```python
import torch

def _softmax(x, axis=-1):
    return torch.softmax(x, dim=axis)
def _gelu(x):
    return torch.nn.functional.gelu(x, approximate="tanh")
def _silu(x):
    return torch.nn.functional.silu(x)
def _sigmoid(x):
    return torch.sigmoid(x)
def _layernorm(x, axis=-1, eps=1e-5):
    m = x.mean(dim=axis, keepdim=True)
    v = x.var(dim=axis, keepdim=True, unbiased=False)
    return (x - m) / torch.sqrt(v + eps)
def _scatter_add(tgt, idx, src, axis=0):
    return tgt.clone().index_add_(axis, idx, src)
def _segment_sum(src, seg, n):
    out = torch.zeros((n,) + src.shape[1:], dtype=src.dtype)
    return out.index_add_(0, seg, src)
def _pad(x, pw):
    flat = tuple(v for pair in reversed(pw) for v in pair)
    return torch.nn.functional.pad(x, flat)

kernel_name = 'interleave_layers__spectral_fnet__moe_arch_mod__prompt'

def setup_inputs():

    _w = (lambda a: (lambda t: t.to(torch.bfloat16) if t.is_floating_point() else t)(torch.as_tensor(a)))
    def _A_setup():
        B, S, D = 1, 2048, 512
        ns = torch.arange(S)[:, None] * torch.arange(S)[None, :]
        nd = torch.arange(D)[:, None] * torch.arange(D)[None, :]
        Ws_re = torch.cos(-2.0 * torch.pi * ns / S).to(float)
        Ws_im = torch.sin(-2.0 * torch.pi * ns / S).to(float)
        Wd_re = torch.cos(-2.0 * torch.pi * nd / D).to(float)
        Wd_im = torch.sin(-2.0 * torch.pi * nd / D).to(float)
        return {
            "x": _w((lambda *s: torch.randn(*s, dtype=torch.bfloat16) * 0.05)(B, S, D)),
            "dft_seq_re": _w(Ws_re),
            "dft_seq_im": _w(Ws_im),
            "dft_hid_re": _w(Wd_re),
            "dft_hid_im": _w(Wd_im),
        }
    _A_in = _A_setup()

    def _B_setup():
        B, S, D, F, C = 1, 2048, 512, 1792, 2
        return {
            "x": _w((lambda *s: torch.randn(*s, dtype=torch.bfloat16) * 0.05)(B, S, D)),
            "w_r": _w((lambda *s: torch.randn(*s, dtype=torch.bfloat16) * 1.6)(D)),
            "w_gate": _w((lambda *s: torch.randn(*s, dtype=torch.bfloat16) * 0.4)(D, F)),
            "w_up": _w((lambda *s: torch.randn(*s, dtype=torch.bfloat16) * 0.4)(D, F)),
            "w_down": _w((lambda *s: torch.randn(*s, dtype=torch.bfloat16) * 0.4)(F, D)),
        }
    _B_in = _B_setup()

    return {
        "A_x": _A_in["x"],
        "A_dft_seq_re": _A_in["dft_seq_re"],
        "A_dft_seq_im": _A_in["dft_seq_im"],
        "A_dft_hid_re": _A_in["dft_hid_re"],
        "A_dft_hid_im": _A_in["dft_hid_im"],
        "B_x": _B_in["x"],
        "B_w_r": _B_in["w_r"],
        "B_w_gate": _B_in["w_gate"],
        "B_w_up": _B_in["w_up"],
        "B_w_down": _B_in["w_down"],
    }

def reference(A_x, A_dft_seq_re, A_dft_seq_im, A_dft_hid_re, A_dft_hid_im, B_x, B_w_r, B_w_gate, B_w_up, B_w_down):
    def _A_ref(x, dft_seq_re, dft_seq_im, dft_hid_re, dft_hid_im):
        a = torch.einsum("bsd,ed->bse", x, dft_hid_re)
        b = torch.einsum("bsd,ed->bse", x, dft_hid_im)
        y = torch.einsum("ts,bse->bte", dft_seq_re, a) - torch.einsum("ts,bse->bte", dft_seq_im, b)
        return y

    def _B_ref(x, w_r, w_gate, w_up, w_down):
        B, S, D = x.shape
        C = 2
        r = x @ w_r
        idx = torch.argsort(-r, axis=-1)[:, :C]
        idx_e = (lambda x, n, axis: torch.repeat_interleave(x, n, dim=axis))(idx.reshape(B, C, 1), D, axis=2)
        x_sel = (lambda x, i, axis: torch.take_along_dim(x, i, dim=axis))(x, idx_e, axis=1)
        g = _silu(x_sel @ w_gate)
        u = x_sel @ w_up
        y = (g * u) @ w_down
        r_sel = _sigmoid((lambda x, i, axis: torch.take_along_dim(x, i, dim=axis))(r, idx, axis=1))
        y = y * r_sel.reshape(B, C, 1)
        b_off = (torch.arange(B) * S).reshape(B, 1)
        flat_idx = (idx + b_off).reshape(B * C)
        zero = (x * 0.0).reshape(B * S, D)
        upd = _scatter_add(zero, flat_idx, y.reshape(B * C, D), axis=0)
        return x + upd.reshape(B, S, D)

    x = A_x
    x = x + _A_ref(_layernorm(x, axis=-1), A_dft_seq_re, A_dft_seq_im, A_dft_hid_re, A_dft_hid_im)
    x = x + _B_ref(_layernorm(x, axis=-1), B_w_r, B_w_gate, B_w_up, B_w_down)
    x = x + _A_ref(_layernorm(x, axis=-1), A_dft_seq_re, A_dft_seq_im, A_dft_hid_re, A_dft_hid_im)
    x = x + _B_ref(_layernorm(x, axis=-1), B_w_r, B_w_gate, B_w_up, B_w_down)
    return x
```

```asm
; @launch grid=(241,1,1) block=(512,1,1) lds=70208
.amdgcn_target "amdgcn-amd-amdhsa--gfx950"
.text
.globl interleave_layers__spectral_fnet__moe_arch_mod__prompt_kernel
.p2align 8
.type interleave_layers__spectral_fnet__moe_arch_mod__prompt_kernel,@function
interleave_layers__spectral_fnet__moe_arch_mod__prompt_kernel:
s_cmp_ge_u32 s2, 241
s_cbranch_scc1 .END
s_load_dwordx2 s[12:13], s[0:1], 96
s_load_dwordx2 s[8:9], s[0:1], 0
s_load_dwordx2 s[24:25], s[0:1], 48
s_load_dwordx2 s[16:17], s[0:1], 80
s_load_dwordx2 s[28:29], s[0:1], 56
s_load_dwordx2 s[32:33], s[0:1], 64
s_load_dwordx2 s[36:37], s[0:1], 72
s_getpc_b64 s[20:21]
s_add_u32 s20, s20, ftabs@rel32@lo+4
s_addc_u32 s21, s21, ftabs@rel32@hi+12
s_mov_b32 s10, 2097152
s_mov_b32 s11, 0x20000
s_mov_b32 s14, 16777216
s_mov_b32 s15, 0x20000
s_mov_b32 s18, 2097152
s_mov_b32 s19, 0x20000
s_mov_b32 s22, 25600
s_mov_b32 s23, 0x20000
s_mov_b32 s26, 1024
s_mov_b32 s27, 0x20000
s_mov_b32 s30, 1835008
s_mov_b32 s31, 0x20000
s_mov_b32 s34, 1835008
s_mov_b32 s35, 0x20000
s_mov_b32 s38, 1835008
s_mov_b32 s39, 0x20000
v_lshrrev_b32 v1, 6, v0
v_lshlrev_b32 v4, 4, v0
v_readfirstlane_b32 s3, v1
v_and_b32 v1, 63, v0
v_and_b32 v2, 15, v0
v_bfe_u32 v3, v0, 4, 2
s_mov_b32 s44, 0
s_mov_b32 s45, 100000
s_mov_b32 s72, 1
s_mov_b32 s73, 1
s_and_b32 s43, s3, 3
s_lshr_b32 s5, s3, 2
s_mov_b32 s48, 2113536
s_cmp_ge_u32 s2, 129
s_cselect_b32 s49, s5, 0
s_cmp_eq_u32 s49, 0
s_cbranch_scc1 .NOW
.WARM:
v_lshlrev_b32 v235, 7, v0
v_subrev_u32 v235, 32768, v235
buffer_load_dword v236, v235, s[20:23], 0 offen
s_getpc_b64 s[20:21]
.WPC:
s_mov_b32 s22, .END-.WPC
buffer_load_dword v237, v235, s[20:23], 0 offen
s_endpgm
.NOW:
v_lshlrev_b32 v5, 6, v2
s_lshl_b32 s75, s2, 1
s_add_u32 s75, s75, s5
s_lshl_b32 s68, s43, 9
s_add_u32 s68, s68, s75
s_sub_u32 s69, 2048, s68
s_and_b32 s69, s69, 2047
s_lshl_b32 s68, s68, 10
s_lshl_b32 s69, s69, 10
v_lshl_add_u32 v5, v3, 4, v5
v_lshlrev_b32 v235, 4, v1
v_sub_u32 v6, 1008, v5
v_sub_u32 v7, 1024, v5
v_and_b32 v7, 1023, v7
s_cmp_ge_u32 s2, 129
s_waitcnt lgkmcnt(0)
s_load_dword s42, s[12:13], s48
s_cbranch_scc1 .FFN
buffer_load_dwordx4 v[136:139], v5, s[8:11], s68 offen
buffer_load_dwordx4 v[140:143], v6, s[8:11], s69 offen
buffer_load_ushort v144, v7, s[8:11], s69 offen
v_mov_b32 v180, -1
v_mov_b32 v181, -1
v_mov_b32 v182, -1
v_mov_b32 v183, -1
s_mul_i32 s6, s2, 8448
s_add_u32 s6, s6, 2228224
s_mul_i32 s4, s5, 13568
buffer_store_dwordx4 v[180:183], v4, s[12:15], s6 offen sc1
s_lshl_b32 s48, s3, 3
v_lshl_add_u32 v160, v3, 1, s48
v_mul_u32_u24 v161, v160, v2
v_add_u32 v162, v161, v2
v_lshl_add_u32 v163, v160, 4, v161
v_lshl_add_u32 v160, v160, 4, v162
v_add_u32 v160, 16, v160
v_cvt_f32_u32 v161, v161
v_mul_f32 v161, 0x3a000000, v161
v_cos_f32 v56, v161
v_sin_f32 v58, v161
v_cvt_f32_u32 v162, v162
v_mul_f32 v162, 0x3a000000, v162
v_cos_f32 v57, v162
v_sin_f32 v59, v162
v_cvt_f32_u32 v163, v163
v_mul_f32 v163, 0x3a000000, v163
v_cos_f32 v60, v163
v_sin_f32 v62, v163
v_cvt_f32_u32 v160, v160
v_mul_f32 v160, 0x3a000000, v160
v_cos_f32 v61, v160
v_sin_f32 v63, v160
v_mul_f32 v56, 0x3e000000, v56
v_mul_f32 v57, 0x3e000000, v57
v_mul_f32 v58, 0x3e000000, v58
v_mul_f32 v59, 0x3e000000, v59
v_mul_f32 v60, 0x3e000000, v60
v_mul_f32 v61, 0x3e000000, v61
v_mul_f32 v62, 0x3e000000, v62
v_mul_f32 v63, 0x3e000000, v63
v_lshlrev_b32 v204, 2, v5
v_lshl_add_u32 v204, v2, 3, v204
s_lshl_b32 s48, s43, 1
s_add_u32 s48, s48, s4
v_add_u32 v204, s48, v204
v_lshrrev_b32 v160, 3, v0
v_and_b32 v161, 1, v0
v_and_b32 v162, 4, v0
v_lshl_add_u32 v163, v161, 7, v160
v_add_u32 v206, 64, v163
v_cmp_eq_u32 vcc, 0, v163
v_mov_b32 v205, 256
s_nop 0
v_cndmask_b32 v205, v163, v205, vcc
v_cmp_ne_u32 vcc, 0, v162
v_bfe_u32 v162, v0, 1, 1
v_mul_u32_u24 v162, 13568, v162
v_sub_u32 v163, 512, v205
v_cndmask_b32 v205, v205, v163, vcc
v_lshrrev_b32 v163, 5, v205
v_add_lshl_u32 v205, v205, v163, 3
v_add_u32 v205, v205, v162
v_sub_u32 v163, 512, v206
v_cndmask_b32 v206, v206, v163, vcc
v_lshrrev_b32 v163, 5, v206
v_add_lshl_u32 v206, v206, v163, 3
v_add_u32 v206, v206, v162
v_mul_u32_u24 v207, 16512, v160
v_and_b32 v163, 7, v0
v_lshl_add_u32 v207, v163, 4, v207
s_lshl_b32 s48, s2, 7
v_add_u32 v207, s48, v207
s_mul_i32 s46, s75, 8960
s_add_u32 s46, s46, 3407872
s_mul_i32 s7, s2, 17920
s_add_u32 s7, s7, 3416320
s_mov_b32 s49, 8192
s_mov_b32 s50, 16384
s_mov_b32 s51, 24576
s_waitcnt vmcnt(1)
buffer_load_dwordx4 v[236:239], v4, s[20:23], 0 offen
buffer_load_dwordx4 v[240:243], v4, s[20:23], s49 offen
buffer_load_dwordx4 v[244:247], v4, s[20:23], s50 offen
buffer_load_dwordx4 v[252:255], v235, s[20:23], s51 offen
v_lshlrev_b32 v8, 16, v136
v_and_b32 v9, 0xffff0000, v136
v_lshlrev_b32 v10, 16, v137
v_and_b32 v11, 0xffff0000, v137
v_lshlrev_b32 v12, 16, v138
v_and_b32 v13, 0xffff0000, v138
v_lshlrev_b32 v14, 16, v139
v_and_b32 v15, 0xffff0000, v139
v_lshlrev_b32 v16, 16, v144
v_and_b32 v17, 0xffff0000, v143
v_lshlrev_b32 v18, 16, v143
v_and_b32 v19, 0xffff0000, v142
v_lshlrev_b32 v20, 16, v142
v_and_b32 v21, 0xffff0000, v141
v_lshlrev_b32 v22, 16, v141
v_and_b32 v23, 0xffff0000, v140
v_pk_add_f32 v[160:161], v[8:9], v[10:11]
v_pk_mul_f32 v[164:165], v[8:9], v[8:9]
v_pk_add_f32 v[162:163], v[16:17], v[18:19]
v_pk_mul_f32 v[166:167], v[16:17], v[16:17]
v_pk_fma_f32 v[164:165], v[10:11], v[10:11], v[164:165]
v_pk_fma_f32 v[166:167], v[18:19], v[18:19], v[166:167]
v_pk_add_f32 v[160:161], v[160:161], v[12:13]
v_pk_fma_f32 v[164:165], v[12:13], v[12:13], v[164:165]
v_pk_add_f32 v[162:163], v[162:163], v[20:21]
v_pk_fma_f32 v[166:167], v[20:21], v[20:21], v[166:167]
v_pk_add_f32 v[160:161], v[160:161], v[14:15]
v_pk_fma_f32 v[164:165], v[14:15], v[14:15], v[164:165]
v_pk_add_f32 v[162:163], v[162:163], v[22:23]
v_pk_fma_f32 v[166:167], v[22:23], v[22:23], v[166:167]
v_add_f32 v160, v160, v161
v_add_f32 v162, v162, v163
v_add_f32 v164, v164, v165
v_add_f32 v166, v166, v167
v_permlane32_swap_b32 v160, v162
s_nop 0
v_permlane32_swap_b32 v164, v166
v_add_f32 v218, v160, v162
v_add_f32 v219, v164, v166
s_nop 1
v_permlane16_swap_b32 v218, v219
v_add_f32 v218, v218, v219
s_nop 1
v_add_f32_dpp v218, v218, v218 row_ror:8 row_mask:0xf bank_mask:0xf
s_nop 1
v_add_f32_dpp v218, v218, v218 row_ror:4 row_mask:0xf bank_mask:0xf
s_nop 1
v_add_f32_dpp v218, v218, v218 row_ror:2 row_mask:0xf bank_mask:0xf
s_nop 1
v_add_f32_dpp v219, v218, v218 row_ror:1 row_mask:0xf bank_mask:0xf
v_add_f32_dpp v218, v218, v218 row_ror:1 row_mask:0xf bank_mask:0xf
s_nop 1
v_permlane16_swap_b32 v218, v219
v_mul_f32 v194, 0x3b000000, v218
v_mul_f32 v219, 0x3b000000, v219
v_fma_f32 v219, -v194, v194, v219
v_add_f32 v218, 0x3727c5ac, v219
v_rsq_f32 v196, v218
s_nop 0
v_mul_f32 v160, v194, v196
v_mov_b32 v197, v196
v_mul_f32 v161, v194, v196
s_nop 0
v_permlane32_swap_b32 v196, v197
v_permlane32_swap_b32 v160, v161
v_add_f32 v160, v160, v161
v_pk_fma_f32 v[162:163], v[8:9], v[196:197], v[160:161] op_sel_hi:[1,0,0] neg_lo:[0,0,1] neg_hi:[0,0,1]
v_pk_fma_f32 v[164:165], v[10:11], v[196:197], v[160:161] op_sel_hi:[1,0,0] neg_lo:[0,0,1] neg_hi:[0,0,1]
v_pk_fma_f32 v[166:167], v[12:13], v[196:197], v[160:161] op_sel_hi:[1,0,0] neg_lo:[0,0,1] neg_hi:[0,0,1]
v_pk_fma_f32 v[168:169], v[14:15], v[196:197], v[160:161] op_sel_hi:[1,0,0] neg_lo:[0,0,1] neg_hi:[0,0,1]
v_pk_fma_f32 v[162:163], v[16:17], v[196:197], v[162:163] op_sel:[0,1,0]
v_pk_fma_f32 v[164:165], v[18:19], v[196:197], v[164:165] op_sel:[0,1,0]
v_pk_fma_f32 v[166:167], v[20:21], v[196:197], v[166:167] op_sel:[0,1,0]
v_pk_fma_f32 v[168:169], v[22:23], v[196:197], v[168:169] op_sel:[0,1,0]
v_cvt_pk_f16_f32 v170, v162, v163
v_cvt_pk_f16_f32 v171, v164, v165
v_cvt_pk_f16_f32 v172, v166, v167
v_cvt_pk_f16_f32 v173, v168, v169
ds_write_b16 v204, v170 offset:0
ds_write_b16_d16_hi v204, v170 offset:8
ds_write_b16 v204, v171 offset:16
ds_write_b16_d16_hi v204, v171 offset:24
ds_write_b16 v204, v172 offset:32
ds_write_b16_d16_hi v204, v172 offset:40
ds_write_b16 v204, v173 offset:48
ds_write_b16_d16_hi v204, v173 offset:56
s_waitcnt lgkmcnt(0)
s_mul_i32 s40, s42, 0x9E3779B1
s_add_u32 s40, s40, 0x7F4A7C15
s_xor_b32 s41, s42, 0x5bd1e995
s_mul_i32 s41, s41, 0x85EBCA6B
v_mov_b32 v130, s40
v_mov_b32 v131, s41
v_mov_b32 v134, s40
v_mov_b32 v135, s41
s_waitcnt vmcnt(4)
s_waitcnt lgkmcnt(0)
s_barrier
ds_read_b64 v[128:129], v205
ds_read_b64 v[132:133], v206
s_mov_b32 s48, 1056768
s_waitcnt lgkmcnt(1)
buffer_store_dwordx4 v[128:131], v207, s[12:15], 0 offen sc1
s_waitcnt lgkmcnt(0)
buffer_store_dwordx4 v[132:135], v207, s[12:15], s48 offen sc1
s_waitcnt vmcnt(3)
ds_write_b128 v4, v[236:239] offset:45632
ds_write_b128 v4, v[240:243] offset:53824
ds_write_b128 v4, v[244:247] offset:62016
s_waitcnt lgkmcnt(0)
s_barrier
buffer_load_dwordx4 v[148:151], v5, s[24:27], 0 offen
buffer_load_dwordx4 v[152:155], v6, s[24:27], 0 offen
buffer_load_ushort v156, v7, s[24:27], 0 offen
s_lshr_b32 s50, s43, 1
s_lshl_b32 s50, s50, 12
v_add_u32 v235, 45632, v235
v_add_u32 v160, s50, v235
ds_read_b128 v[40:43], v235 offset:0
ds_read_b128 v[44:47], v235 offset:1024
ds_read_b128 v[48:51], v235 offset:2048
ds_read_b128 v[52:55], v235 offset:3072
ds_read_b128 v[64:67], v160 offset:4096
ds_read_b128 v[68:71], v160 offset:5120
ds_read_b128 v[72:75], v160 offset:6144
ds_read_b128 v[76:79], v160 offset:7168
ds_read_b128 v[80:83], v235 offset:12288
ds_read_b128 v[84:87], v235 offset:13312
ds_read_b128 v[88:91], v235 offset:14336
ds_read_b128 v[92:95], v235 offset:15360
ds_read_b128 v[96:99], v235 offset:16384
ds_read_b128 v[100:103], v235 offset:17408
ds_read_b128 v[104:107], v235 offset:18432
ds_read_b128 v[108:111], v235 offset:19456
ds_read_b128 v[112:115], v235 offset:20480
ds_read_b128 v[116:119], v235 offset:21504
ds_read_b128 v[120:123], v235 offset:22528
ds_read_b128 v[124:127], v235 offset:23552
v_subrev_u32 v235, 45632, v235
s_cmp_lg_u32 s2, 128
s_cbranch_scc1 .L1
v_and_b32 v172, 0xfff, v4
s_mul_i32 s50, s2, 8448
s_add_u32 s50, s50, 6356992
s_cmp_eq_u32 s5, 0
s_cselect_b64 exec, -1, 0
buffer_store_dwordx4 v[180:183], v172, s[12:15], s46 offen sc1
s_and_b32 s48, s75, 255
s_mul_i32 s48, s48, 256
s_add_u32 s48, s48, 6160384
s_add_u32 s49, s46, 8192
s_cmp_eq_u32 s43, 1
s_cselect_b32 s48, s48, s49
s_cselect_b32 exec_lo, 0xffff, 0xffff
s_cmp_gt_u32 s43, 1
s_cselect_b32 exec_lo, 0, exec_lo
s_mov_b32 exec_hi, 0
buffer_store_dwordx4 v[180:183], v235, s[12:15], s48 offen sc1
s_mov_b64 exec, -1
s_cmp_ge_u32 s2, 64
s_cbranch_scc1 .L2
buffer_store_dwordx4 v[180:183], v4, s[12:15], s50 offen sc1
.L2:
.L1:
v_and_b32 v161, 1, v0
s_lshl_b32 s48, s3, 3
v_lshrrev_b32 v160, 1, v2
v_lshl_add_u32 v162, v3, 6, v160
v_add_u32 v162, s48, v162
v_sub_u32 v163, 256, v162
v_lshrrev_b32 v208, 1, v162
v_lshlrev_b32 v208, 7, v208
v_and_b32 v162, 1, v162
v_lshl_add_u32 v208, v162, 5, v208
v_lshl_add_u32 v208, v161, 4, v208
v_lshrrev_b32 v209, 1, v163
v_lshlrev_b32 v209, 7, v209
v_and_b32 v163, 1, v163
v_lshl_add_u32 v209, v163, 5, v209
v_lshl_add_u32 v209, v161, 4, v209
s_mul_i32 s70, s2, 16512
v_mul_u32_u24 v210, 144, v2
v_lshl_add_u32 v210, v3, 2, v210
s_lshl_b32 s48, s3, 4
s_add_u32 s48, s48, 27200
v_add_u32 v210, s48, v210
s_and_b32 s50, s43, 1
s_lshl_b32 s50, s50, 3
v_add_u32 v160, s50, v160
v_mul_u32_u24 v162, 144, v160
v_lshl_add_u32 v162, v3, 4, v162
s_mul_i32 s48, s5, 9216
s_add_u32 s48, s48, 27200
v_add_u32 v162, s48, v162
s_cmp_eq_u32 s2, 0
s_cselect_b32 s51, 1, 3
v_mul_u32_u24 v163, s51, v161
v_xor_b32 v184, 0, v163
v_mul_u32_u24 v184, 2304, v184
v_add_u32 v184, v184, v162
v_xor_b32 v185, 1, v163
v_mul_u32_u24 v185, 2304, v185
v_add_u32 v185, v185, v162
v_xor_b32 v186, 2, v163
v_mul_u32_u24 v186, 2304, v186
v_add_u32 v186, v186, v162
v_xor_b32 v187, 3, v163
v_mul_u32_u24 v187, 2304, v187
v_add_u32 v187, v187, v162
s_lshl_b32 s50, s5, 4
s_lshr_b32 s51, s43, 1
s_lshl_b32 s51, s51, 7
s_add_u32 s50, s50, s51
v_lshl_add_u32 v160, v3, 5, v160
v_add_u32 v160, s50, v160
v_lshrrev_b32 v160, 1, v160
v_mul_u32_u24 v211, 8448, v160
v_and_b32 v160, 3, v0
v_lshl_add_u32 v211, v160, 4, v211
s_lshl_b32 s71, s2, 6
s_add_u32 s71, s71, 2228224
v_lshlrev_b32 v162, 31, v161
v_or_b32 v202, 1.0, v162
v_bfe_u32 v160, v0, 1, 7
s_lshl_b32 s48, s5, 5
v_lshl_add_u32 v214, v160, 6, s48
v_lshl_add_u32 v214, v161, 4, v214
v_mul_u32_u24 v223, 4352, v0
v_sub_u32 v162, 128, v160
v_and_b32 v162, 127, v162
v_cmp_eq_u32 vcc, 1, v161
s_nop 1
v_cndmask_b32 v160, v160, v162, vcc
v_and_b32 v162, 15, v160
v_mul_u32_u24 v212, 80, v162
v_lshrrev_b32 v162, 4, v160
v_lshl_add_u32 v162, v161, 3, v162
v_lshl_add_u32 v212, v162, 2, v212
v_add_u32 v212, s4, v212
v_lshl_add_u32 v160, v161, 8, v160
v_lshlrev_b32 v188, 3, v160
v_add_u32 v189, 1024, v188
v_sub_u32 v190, 4096, v188
v_sub_u32 v191, 3072, v188
v_and_b32 v190, 4095, v190
v_and_b32 v191, 4095, v191
v_mul_u32_u24 v213, 80, v2
v_lshl_add_u32 v213, v3, 4, v213
s_mul_i32 s48, s43, 1280
s_add_u32 s48, s48, s4
v_add_u32 v213, s48, v213
v_add_u32 v160, 16, v5
v_bfe_u32 v162, v160, 6, 4
v_bfe_u32 v160, v160, 4, 2
v_lshl_add_u32 v160, v160, 4, v162
v_lshlrev_b32 v215, 2, v160
s_lshl_b32 s48, s75, 2
s_add_u32 s48, s48, s43
s_lshl_b32 s48, s48, 1
v_lshrrev_b32 v160, 5, v1
v_or_b32 v216, s48, v160
s_lshl_b32 s48, s43, 5
v_lshl_add_u32 v222, v160, 4, s48
s_lshl_b32 s48, s3, 3
v_lshl_add_u32 v224, v160, 2, s48
s_cmp_ge_u32 s2, 59
s_cselect_b32 s48, -59, 53
s_lshl_b32 s48, s48, 8
s_sub_u32 s48, s48, 32
s_lshl_b32 s49, s2, 8
s_add_u32 s49, s49, 2129920
v_bfe_u32 v227, v0, 1, 1
v_mul_lo_u32 v227, v227, s48
v_add3_u32 v227, v227, v235, s49
s_and_b32 s48, s75, 255
s_cselect_b32 vcc_hi, -1, 0
s_mov_b32 vcc_lo, -1
s_cmp_eq_u32 s75, 257
s_cselect_b64 vcc, 0, vcc
v_mov_b32 v226, 0xfffff000
v_cndmask_b32 v226, 0, v226, vcc
v_cndmask_b32 v216, 0, v216, vcc
s_waitcnt vmcnt(0) lgkmcnt(0)
v_lshlrev_b32 v24, 16, v148
v_and_b32 v25, 0xffff0000, v148
v_lshlrev_b32 v26, 16, v149
v_and_b32 v27, 0xffff0000, v149
v_lshlrev_b32 v28, 16, v150
v_and_b32 v29, 0xffff0000, v150
v_lshlrev_b32 v30, 16, v151
v_and_b32 v31, 0xffff0000, v151
v_lshlrev_b32 v32, 16, v156
v_and_b32 v33, 0xffff0000, v155
v_lshlrev_b32 v34, 16, v155
v_and_b32 v35, 0xffff0000, v154
v_lshlrev_b32 v36, 16, v154
v_and_b32 v37, 0xffff0000, v153
v_lshlrev_b32 v38, 16, v153
v_and_b32 v39, 0xffff0000, v152
v_pk_add_f32 v[160:161], v[24:25], v[26:27]
v_pk_add_f32 v[162:163], v[28:29], v[30:31]
v_pk_add_f32 v[160:161], v[160:161], v[162:163]
v_add_f32 v160, v160, v161
v_mov_b32 v161, v160
s_nop 1
v_permlane32_swap_b32 v160, v161
v_add_f32 v160, v160, v161
v_mov_b32 v161, v160
s_nop 1
v_permlane16_swap_b32 v160, v161
v_add_f32 v203, v160, v161
s_nop 1
v_add_f32_dpp v203, v203, v203 row_ror:8 row_mask:0xf bank_mask:0xf
s_nop 1
v_add_f32_dpp v203, v203, v203 row_ror:4 row_mask:0xf bank_mask:0xf
s_nop 1
v_add_f32_dpp v203, v203, v203 row_ror:2 row_mask:0xf bank_mask:0xf
s_nop 1
v_add_f32_dpp v203, v203, v203 row_ror:1 row_mask:0xf bank_mask:0xf
.TOP:
s_waitcnt vmcnt(0)
s_cmp_eq_u32 s2, 128
s_cbranch_scc1 .HPH
.L3:
buffer_load_dwordx4 v[136:139], v208, s[12:15], s70 offen sc1
buffer_load_dwordx4 v[140:143], v209, s[12:15], s70 offen offset:64 sc1
s_waitcnt vmcnt(0)
v_cmp_ne_u64 vcc, v[138:139], s[40:41]
v_cmp_ne_u64 s[52:53], v[142:143], s[40:41]
s_or_b64 vcc, vcc, s[52:53]
s_cbranch_vccz .L4
s_mov_b64 exec, vcc
s_sub_i32 s45, s45, 1
s_cmp_gt_i32 s45, 0
s_cbranch_scc1 .L3
.L4:
s_mov_b64 exec, -1
v_mov_b64 v[138:139], v[140:141]
s_nop 1
v_mfma_f32_16x16x32_f16 v[236:239], v[136:139], v[40:43], 0
v_mfma_f32_16x16x32_f16 v[240:243], v[136:139], v[44:47], 0
v_mfma_f32_16x16x32_f16 v[244:247], v[136:139], v[48:51], 0
v_mfma_f32_16x16x32_f16 v[248:251], v[136:139], v[52:55], 0
s_nop 4
v_pk_mul_f32 v[144:145], v[236:237], v[56:57] op_sel_hi:[1,0]
v_pk_mul_f32 v[148:149], v[240:241], v[56:57] op_sel_hi:[1,0]
v_pk_mul_f32 v[146:147], v[238:239], v[56:57] op_sel:[0,1]
v_pk_mul_f32 v[150:151], v[242:243], v[56:57] op_sel:[0,1]
v_pk_fma_f32 v[144:145], v[240:241], v[58:59], v[144:145] op_sel_hi:[1,0,1]
v_pk_fma_f32 v[148:149], v[236:237], v[58:59], v[148:149] op_sel_hi:[1,0,1] neg_lo:[0,1,0] neg_hi:[0,1,0]
v_pk_fma_f32 v[146:147], v[242:243], v[58:59], v[146:147] op_sel:[0,1,0]
v_pk_fma_f32 v[150:151], v[238:239], v[58:59], v[150:151] op_sel:[0,1,0] neg_lo:[0,1,0] neg_hi:[0,1,0]
v_cvt_pk_f16_f32 v160, v144, v146
v_cvt_pk_f16_f32 v161, v148, v150
ds_write2st64_b32 v210, v160, v161 offset0:0 offset1:9
v_cvt_pk_f16_f32 v162, v145, v147
v_cvt_pk_f16_f32 v163, v149, v151
ds_write2st64_b32 v210, v162, v163 offset0:18 offset1:27
v_pk_mul_f32 v[152:153], v[244:245], v[60:61] op_sel_hi:[1,0]
v_pk_mul_f32 v[156:157], v[248:249], v[60:61] op_sel_hi:[1,0]
v_pk_mul_f32 v[154:155], v[246:247], v[60:61] op_sel:[0,1]
v_pk_mul_f32 v[158:159], v[250:251], v[60:61] op_sel:[0,1]
v_pk_fma_f32 v[152:153], v[248:249], v[62:63], v[152:153] op_sel_hi:[1,0,1]
v_pk_fma_f32 v[156:157], v[244:245], v[62:63], v[156:157] op_sel_hi:[1,0,1] neg_lo:[0,1,0] neg_hi:[0,1,0]
v_pk_fma_f32 v[154:155], v[250:251], v[62:63], v[154:155] op_sel:[0,1,0]
v_pk_fma_f32 v[158:159], v[246:247], v[62:63], v[158:159] op_sel:[0,1,0] neg_lo:[0,1,0] neg_hi:[0,1,0]
v_cvt_pk_f16_f32 v164, v152, v154
v_cvt_pk_f16_f32 v165, v156, v158
ds_write2st64_b32 v210, v164, v165 offset0:36 offset1:45
v_cvt_pk_f16_f32 v166, v153, v155
v_cvt_pk_f16_f32 v167, v157, v159
ds_write2st64_b32 v210, v166, v167 offset0:54 offset1:63
s_waitcnt lgkmcnt(0)
s_barrier
ds_read_b128 v[136:139], v184 offset:0
ds_read_b128 v[144:147], v185 offset:0
ds_read_b128 v[152:155], v186 offset:0
ds_read_b128 v[160:163], v187 offset:0
ds_read_b128 v[140:143], v184 offset:64
ds_read_b128 v[148:151], v185 offset:64
ds_read_b128 v[156:159], v186 offset:64
ds_read_b128 v[164:167], v187 offset:64
s_waitcnt lgkmcnt(7)
v_mfma_f32_16x16x32_f16 v[236:239], v[64:67], v[136:139], 0
s_waitcnt lgkmcnt(6)
v_mfma_f32_16x16x32_f16 v[240:243], v[72:75], v[144:147], 0
s_waitcnt lgkmcnt(5)
v_mfma_f32_16x16x32_f16 v[244:247], v[64:67], v[152:155], 0
s_waitcnt lgkmcnt(4)
v_mfma_f32_16x16x32_f16 v[248:251], v[72:75], v[160:163], 0
s_waitcnt lgkmcnt(3)
v_mfma_f32_16x16x32_f16 v[236:239], v[68:71], v[140:143], v[236:239]
s_waitcnt lgkmcnt(2)
v_mfma_f32_16x16x32_f16 v[240:243], v[76:79], v[148:151], v[240:243]
s_waitcnt lgkmcnt(1)
v_mfma_f32_16x16x32_f16 v[244:247], v[68:71], v[156:159], v[244:247]
s_waitcnt lgkmcnt(0)
v_mfma_f32_16x16x32_f16 v[248:251], v[76:79], v[164:167], v[248:251]
s_nop 3
v_pk_fma_f32 v[236:237], v[240:241], v[202:203], v[236:237] op_sel_hi:[1,0,1]
v_pk_fma_f32 v[238:239], v[242:243], v[202:203], v[238:239] op_sel_hi:[1,0,1]
s_nop 1
v_pk_fma_f32 v[244:245], v[248:249], v[202:203], v[244:245] op_sel_hi:[1,0,1]
v_pk_fma_f32 v[246:247], v[250:251], v[202:203], v[246:247] op_sel_hi:[1,0,1]
v_cvt_pk_f16_f32 v168, v236, v244
v_cvt_pk_f16_f32 v169, v237, v245
v_cvt_pk_f16_f32 v170, v238, v246
v_cvt_pk_f16_f32 v171, v239, v247
buffer_store_dwordx4 v[168:171], v211, s[12:15], s71 offen sc1
s_cmp_lg_u32 s3, 0
s_cbranch_scc1 .L5
v_mfma_f32_16x16x32_f16 v[236:239], v[80:83], v[136:139], 0
v_mfma_f32_16x16x32_f16 v[240:243], v[88:91], v[144:147], 0
v_mfma_f32_16x16x32_f16 v[244:247], v[80:83], v[152:155], 0
v_mfma_f32_16x16x32_f16 v[248:251], v[88:91], v[160:163], 0
v_mfma_f32_16x16x32_f16 v[236:239], v[84:87], v[140:143], v[236:239]
v_mfma_f32_16x16x32_f16 v[240:243], v[92:95], v[148:151], v[240:243]
v_mfma_f32_16x16x32_f16 v[244:247], v[84:87], v[156:159], v[244:247]
v_mfma_f32_16x16x32_f16 v[248:251], v[92:95], v[164:167], v[248:251]
s_nop 5
v_pk_fma_f32 v[236:237], v[240:241], v[202:203], v[236:237] op_sel_hi:[1,0,1]
v_pk_fma_f32 v[238:239], v[242:243], v[202:203], v[238:239] op_sel_hi:[1,0,1]
v_pk_fma_f32 v[244:245], v[248:249], v[202:203], v[244:245] op_sel_hi:[1,0,1]
v_pk_fma_f32 v[246:247], v[250:251], v[202:203], v[246:247] op_sel_hi:[1,0,1]
v_cvt_pk_f16_f32 v168, v236, v244
v_cvt_pk_f16_f32 v169, v237, v245
v_cvt_pk_f16_f32 v170, v238, v246
v_cvt_pk_f16_f32 v171, v239, v247
s_add_u32 s48, s71, 1081344
s_mov_b64 exec, 15
buffer_store_dwordx4 v[168:171], v211, s[12:15], s48 offen sc1
s_mov_b64 exec, -1
.L5:
s_cmp_lg_u32 s44, 0
s_cbranch_scc1 .L6
v_and_b32 v172, 0xfff, v4
s_mul_i32 s50, s2, 8448
s_add_u32 s50, s50, 6356992
s_cmp_eq_u32 s5, 0
s_cselect_b64 exec, -1, 0
buffer_store_dwordx4 v[180:183], v172, s[12:15], s46 offen sc1
s_and_b32 s48, s75, 255
s_mul_i32 s48, s48, 256
s_add_u32 s48, s48, 6160384
s_add_u32 s49, s46, 8192
s_cmp_eq_u32 s43, 1
s_cselect_b32 s48, s48, s49
s_cselect_b32 exec_lo, 0xffff, 0xffff
s_cmp_gt_u32 s43, 1
s_cselect_b32 exec_lo, 0, exec_lo
s_mov_b32 exec_hi, 0
buffer_store_dwordx4 v[180:183], v235, s[12:15], s48 offen sc1
s_mov_b64 exec, -1
s_cmp_ge_u32 s2, 64
s_cbranch_scc1 .L7
buffer_store_dwordx4 v[180:183], v4, s[12:15], s50 offen sc1
.L7:
.L6:
.HPH:
s_cmp_eq_u32 s44, 0
s_cbranch_scc1 .L8
v_mov_b32 v140, 0
.L9:
buffer_load_dwordx4 v[136:139], v140, s[12:15], s7 offen sc1
s_waitcnt vmcnt(0)
v_cmp_ne_u64 vcc, v[138:139], s[40:41]
s_cbranch_vccz .L10
s_mov_b64 exec, vcc
s_sleep 2
s_sub_i32 s45, s45, 1
s_cmp_gt_i32 s45, 0
s_cbranch_scc1 .L9
.L10:
s_mov_b64 exec, -1
v_readfirstlane_b32 s58, v136
v_readfirstlane_b32 s59, v137
v_and_b32 v138, 4, v0
v_cmp_eq_u32 vcc, 0, v138
s_nop 1
v_cndmask_b32 v136, v137, v136, vcc
v_bfe_u32 v137, v136, 3, 9
v_bfe_u32 v138, v136, 1, 2
v_lshl_add_u32 v137, v138, 9, v137
v_and_b32 v138, 3, v0
v_lshlrev_b32 v138, 9, v138
v_add_u32 v138, s75, v138
v_mul_u32_u24 v137, v137, v138
v_and_b32 v137, 2047, v137
v_cvt_f32_u32 v137, v137
v_mul_f32 v137, 0x3a000000, v137
v_cos_f32 v138, v137
v_sin_f32 v139, v137
v_lshlrev_b32 v136, 31, v136
v_mul_f32 v138, 0x3e000000, v138
v_xor_b32 v139, v136, v139
v_mul_f32 v136, 0x3e000000, v139
v_add_f32 v137, v138, v136
v_sub_f32 v138, v138, v136
v_cvt_pk_f16_f32 v136, v137, v138
s_nop 0
v_readlane_b32 s60, v136, 0
v_readlane_b32 s61, v136, 1
v_readlane_b32 s62, v136, 2
v_readlane_b32 s63, v136, 3
v_readlane_b32 s64, v136, 4
v_readlane_b32 s65, v136, 5
v_readlane_b32 s66, v136, 6
v_readlane_b32 s67, v136, 7
.L8:
s_waitcnt vmcnt(0)
s_waitcnt vmcnt(0)
.L11:
buffer_load_dwordx4 v[176:179], v214, s[12:15], s6 offen sc1
s_waitcnt vmcnt(0)
v_max3_u32 v136, v176, v177, v178
v_max_u32 v136, v136, v179
v_cmp_eq_u32 vcc, -1, v136
s_cbranch_vccz .L12
s_mov_b64 exec, vcc
s_sub_i32 s45, s45, 1
s_cmp_gt_i32 s45, 0
s_cbranch_scc1 .L11
.L12:
s_mov_b64 exec, -1
s_cmp_eq_u32 s44, 0
s_cbranch_scc1 .L13
.COR:
s_and_b32 s48, s2, 15
s_lshl_b32 s48, s48, 12
s_add_u32 s48, s48, 6160384
s_mov_b32 s50, 0x07060302
s_mov_b32 s49, 0x05040100
s_bfe_u32 s51, s58, 0x90003
s_cmp_eq_u32 s51, s75
s_cselect_b32 s52, 1, 0
s_bfe_u32 s51, s59, 0x90003
s_cmp_eq_u32 s51, s75
s_cselect_b32 s52, 1, s52
s_lshl_b32 s51, s43, 2
s_add_u32 s51, s51, s4
v_lshl_add_u32 v172, v3, 4, s51
v_and_or_b32 v173, v0, 32, s4
.L14:
buffer_load_dwordx2 v[136:137], v140, s[12:15], s7 offen offset:136 sc1
s_waitcnt vmcnt(0)
v_cmp_ne_u64 vcc, v[136:137], s[40:41]
s_cbranch_vccz .L15
s_mov_b64 exec, vcc
s_sleep 1
s_sub_i32 s45, s45, 1
s_cmp_gt_i32 s45, 0
s_cbranch_scc1 .L14
.L15:
s_mov_b64 exec, -1
.L16:
buffer_load_dwordx2 v[136:137], v188, s[12:15], s48 offen sc1
buffer_load_dwordx2 v[138:139], v189, s[12:15], s48 offen sc1
buffer_load_dwordx2 v[140:141], v190, s[12:15], s48 offen sc1
buffer_load_dwordx2 v[142:143], v191, s[12:15], s48 offen sc1
s_waitcnt vmcnt(0)
v_max3_u32 v145, v136, v137, v138
v_max3_u32 v145, v145, v139, v140
v_max3_u32 v145, v145, v141, v142
v_max_u32 v145, v145, v143
v_cmp_eq_u32 vcc, -1, v145
s_cbranch_vccz .L17
s_mov_b64 exec, vcc
s_sleep 1
s_sub_i32 s45, s45, 1
s_cmp_gt_i32 s45, 0
s_cbranch_scc1 .L16
.L17:
s_mov_b64 exec, -1
v_cvt_f32_f16 v144, v136
v_cvt_f32_f16 v145, v137
v_cvt_f32_f16 v146, v138
v_cvt_f32_f16 v147, v139
v_pk_add_f32 v[148:149], v[144:145], v[146:147]
v_pk_mul_f32 v[150:151], v[144:145], v[144:145]
v_pk_fma_f32 v[150:151], v[146:147], v[146:147], v[150:151]
s_cmp_eq_u32 s52, 0
s_cbranch_scc1 .L18
v_add_u32 v160, s4, v188
ds_write_b64 v160, v[144:145] offset:9472
ds_write_b64 v160, v[146:147] offset:10496
.L18:
v_permlane32_swap_b32 v148, v149
v_permlane32_swap_b32 v150, v151
v_add_f32 v148, v148, v149
v_add_f32 v150, v150, v151
v_perm_b32 v152, v138, v136, s49
v_perm_b32 v156, v138, v136, s50
v_permlane16_swap_b32 v148, v150
v_add_f32 v148, v148, v150
v_perm_b32 v153, v139, v137, s49
v_perm_b32 v157, v139, v137, s50
v_add_f32_dpp v148, v148, v148 row_ror:8 row_mask:0xf bank_mask:0xf
v_perm_b32 v154, v142, v140, s49
v_perm_b32 v158, v142, v140, s50
v_add_f32_dpp v148, v148, v148 row_ror:4 row_mask:0xf bank_mask:0xf
v_perm_b32 v155, v143, v141, s49
v_perm_b32 v159, v143, v141, s50
v_add_f32_dpp v148, v148, v148 row_ror:2 row_mask:0xf bank_mask:0xf
s_nop 1
v_add_f32_dpp v148, v148, v148 row_ror:1 row_mask:0xf bank_mask:0xf
ds_write_b32 v172, v148 offset:4224
s_waitcnt lgkmcnt(0)
s_barrier
ds_read_b128 v[136:139], v173 offset:4224
ds_read_b128 v[140:143], v173 offset:4240
s_cmp_eq_u32 s52, 0
s_cbranch_scc1 .L19
s_lshl_b32 s51, s75, 2
s_add_u32 s51, s51, s43
s_bfe_u32 s54, s58, 0xb0001
s_cmp_lg_u32 s54, s51
s_cbranch_scc1 .L20
s_bitcmp1_b32 s58, 0
s_cbranch_scc1 .L21
v_lshl_add_u32 v144, v5, 2, s4
v_readlane_b32 s54, v194, 0
ds_read_b32 v8, v144 offset:9472
ds_read_b32 v9, v144 offset:9480
ds_read_b32 v10, v144 offset:9488
ds_read_b32 v11, v144 offset:9496
ds_read_b32 v12, v144 offset:9504
ds_read_b32 v13, v144 offset:9512
ds_read_b32 v14, v144 offset:9520
ds_read_b32 v15, v144 offset:9528
s_waitcnt lgkmcnt(0)
v_fma_f32 v8, v8, 4.0, s54
v_fma_f32 v9, v9, 4.0, s54
v_fma_f32 v10, v10, 4.0, s54
v_fma_f32 v11, v11, 4.0, s54
v_fma_f32 v12, v12, 4.0, s54
v_fma_f32 v13, v13, 4.0, s54
v_fma_f32 v14, v14, 4.0, s54
v_fma_f32 v15, v15, 4.0, s54
s_branch .L20
.L21:
v_lshl_add_u32 v144, v6, 2, s4
v_lshl_add_u32 v145, v7, 2, s4
v_readlane_b32 s54, v194, 32
ds_read_b32 v16, v145 offset:9472
ds_read_b32 v17, v144 offset:9528
ds_read_b32 v18, v144 offset:9520
ds_read_b32 v19, v144 offset:9512
ds_read_b32 v20, v144 offset:9504
ds_read_b32 v21, v144 offset:9496
ds_read_b32 v22, v144 offset:9488
ds_read_b32 v23, v144 offset:9480
s_waitcnt lgkmcnt(0)
v_fma_f32 v16, v16, 4.0, s54
v_fma_f32 v17, v17, 4.0, s54
v_fma_f32 v18, v18, 4.0, s54
v_fma_f32 v19, v19, 4.0, s54
v_fma_f32 v20, v20, 4.0, s54
v_fma_f32 v21, v21, 4.0, s54
v_fma_f32 v22, v22, 4.0, s54
v_fma_f32 v23, v23, 4.0, s54
.L20:
s_bfe_u32 s54, s59, 0xb0001
s_cmp_lg_u32 s54, s51
s_cbranch_scc1 .L22
s_bitcmp1_b32 s59, 0
s_cbranch_scc1 .L23
v_lshl_add_u32 v144, v5, 2, s4
v_readlane_b32 s54, v194, 0
ds_read_b32 v8, v144 offset:9476
ds_read_b32 v9, v144 offset:9484
ds_read_b32 v10, v144 offset:9492
ds_read_b32 v11, v144 offset:9500
ds_read_b32 v12, v144 offset:9508
ds_read_b32 v13, v144 offset:9516
ds_read_b32 v14, v144 offset:9524
ds_read_b32 v15, v144 offset:9532
s_waitcnt lgkmcnt(0)
v_fma_f32 v8, v8, 4.0, s54
v_fma_f32 v9, v9, 4.0, s54
v_fma_f32 v10, v10, 4.0, s54
v_fma_f32 v11, v11, 4.0, s54
v_fma_f32 v12, v12, 4.0, s54
v_fma_f32 v13, v13, 4.0, s54
v_fma_f32 v14, v14, 4.0, s54
v_fma_f32 v15, v15, 4.0, s54
s_branch .L22
.L23:
v_lshl_add_u32 v144, v6, 2, s4
v_lshl_add_u32 v145, v7, 2, s4
v_readlane_b32 s54, v194, 32
ds_read_b32 v16, v145 offset:9476
ds_read_b32 v17, v144 offset:9532
ds_read_b32 v18, v144 offset:9524
ds_read_b32 v19, v144 offset:9516
ds_read_b32 v20, v144 offset:9508
ds_read_b32 v21, v144 offset:9500
ds_read_b32 v22, v144 offset:9492
ds_read_b32 v23, v144 offset:9484
s_waitcnt lgkmcnt(0)
v_fma_f32 v16, v16, 4.0, s54
v_fma_f32 v17, v17, 4.0, s54
v_fma_f32 v18, v18, 4.0, s54
v_fma_f32 v19, v19, 4.0, s54
v_fma_f32 v20, v20, 4.0, s54
v_fma_f32 v21, v21, 4.0, s54
v_fma_f32 v22, v22, 4.0, s54
v_fma_f32 v23, v23, 4.0, s54
.L22:
.L19:
s_waitcnt lgkmcnt(0)
v_pk_add_f32 v[136:137], v[136:137], v[138:139]
v_pk_add_f32 v[140:141], v[140:141], v[142:143]
v_add_f32 v136, v136, v137
v_add_f32 v140, v140, v141
v_mul_f32 v136, 0x3b000000, v136
v_mul_f32 v140, 0x3b000000, v140
v_fma_f32 v140, -v136, v136, v140
v_add_f32 v140, 0x3527c5ac, v140
v_rsq_f32 v140, v140
s_nop 0
v_mul_f32 v136, -v136, v140
v_cvt_pk_f16_f32 v136, v140, v136
v_mov_b32 v137, v136
s_nop 1
v_permlane32_swap_b32 v136, v137
v_pk_fma_f16 v152, v152, v136, v156 op_sel_hi:[1,0,1] neg_lo:[0,0,1] neg_hi:[0,0,1]
v_pk_fma_f16 v153, v153, v137, v157 op_sel_hi:[1,0,1] neg_lo:[0,0,1] neg_hi:[0,0,1]
v_pk_fma_f16 v154, v154, v136, v158 op_sel_hi:[1,0,1] neg_lo:[0,0,1] neg_hi:[0,0,1]
v_pk_fma_f16 v155, v155, v137, v159 op_sel_hi:[1,0,1] neg_lo:[0,0,1] neg_hi:[0,0,1]
v_pk_add_f16 v152, v152, v136 op_sel:[0,1]
v_pk_add_f16 v153, v153, v137 op_sel:[0,1]
v_pk_add_f16 v154, v154, v136 op_sel:[0,1]
v_pk_add_f16 v155, v155, v137 op_sel:[0,1]
v_pk_mul_f16 v140, v152, s60 op_sel_hi:[1,0]
v_pk_mul_f16 v141, v152, s61 op_sel_hi:[1,0]
v_pk_mul_f16 v142, v152, s62 op_sel_hi:[1,0]
v_pk_mul_f16 v143, v152, s63 op_sel_hi:[1,0]
v_pk_fma_f16 v140, v154, s60, v140 op_sel:[0,1,0]
v_pk_fma_f16 v141, v154, s61, v141 op_sel:[0,1,0]
v_pk_fma_f16 v142, v154, s62, v142 op_sel:[0,1,0]
v_pk_fma_f16 v143, v154, s63, v143 op_sel:[0,1,0]
v_pk_fma_f16 v140, v153, s64, v140 op_sel_hi:[1,0,1]
v_pk_fma_f16 v141, v153, s65, v141 op_sel_hi:[1,0,1]
v_pk_fma_f16 v142, v153, s66, v142 op_sel_hi:[1,0,1]
v_pk_fma_f16 v143, v153, s67, v143 op_sel_hi:[1,0,1]
v_pk_fma_f16 v140, v155, s64, v140 op_sel:[0,1,0]
v_pk_fma_f16 v141, v155, s65, v141 op_sel:[0,1,0]
v_pk_fma_f16 v142, v155, s66, v142 op_sel:[0,1,0]
v_pk_fma_f16 v143, v155, s67, v143 op_sel:[0,1,0]
v_pk_add_f16 v176, v176, v140
v_pk_add_f16 v177, v177, v141
v_pk_add_f16 v178, v178, v142
v_pk_add_f16 v179, v179, v143
.L13:
ds_write_b32 v212, v176 offset:4352
ds_write_b32 v212, v177 offset:5632
ds_write_b32 v212, v178 offset:6912
ds_write_b32 v212, v179 offset:8192
s_waitcnt lgkmcnt(0)
s_barrier
ds_read_b128 v[136:139], v213 offset:4352
s_cmp_eq_u32 s44, 0
s_cselect_b64 exec, -1, 0
buffer_store_dwordx4 v[180:183], v4, s[12:15], s6 offen sc1
s_mov_b64 exec, -1
s_waitcnt lgkmcnt(0)
v_mfma_f32_16x16x32_f16 v[236:239], v[136:139], v[96:99], 0
v_mfma_f32_16x16x32_f16 v[240:243], v[136:139], v[100:103], 0
v_mfma_f32_16x16x32_f16 v[244:247], v[136:139], v[104:107], 0
v_mfma_f32_16x16x32_f16 v[248:251], v[136:139], v[108:111], 0
s_nop 4
v_pk_mul_f32 v[160:161], v[236:237], v[112:113]
v_pk_mul_f32 v[164:165], v[240:241], v[112:113]
v_pk_mul_f32 v[162:163], v[238:239], v[114:115]
v_pk_mul_f32 v[166:167], v[242:243], v[114:115]
v_pk_fma_f32 v[160:161], v[240:241], v[116:117], v[160:161]
v_pk_fma_f32 v[164:165], v[236:237], v[116:117], v[164:165] neg_lo:[0,1,0] neg_hi:[0,1,0]
v_pk_fma_f32 v[162:163], v[242:243], v[118:119], v[162:163]
v_pk_fma_f32 v[166:167], v[238:239], v[118:119], v[166:167] neg_lo:[0,1,0] neg_hi:[0,1,0]
v_cvt_pk_f16_f32 v140, v160, v161
v_cvt_pk_f16_f32 v142, v164, v165
v_cvt_pk_f16_f32 v141, v162, v163
v_cvt_pk_f16_f32 v143, v166, v167
v_pk_mul_f32 v[168:169], v[244:245], v[120:121]
v_pk_mul_f32 v[172:173], v[248:249], v[120:121]
v_pk_mul_f32 v[170:171], v[246:247], v[122:123]
v_pk_mul_f32 v[174:175], v[250:251], v[122:123]
v_pk_fma_f32 v[168:169], v[248:249], v[124:125], v[168:169]
v_pk_fma_f32 v[172:173], v[244:245], v[124:125], v[172:173] neg_lo:[0,1,0] neg_hi:[0,1,0]
v_pk_fma_f32 v[170:171], v[250:251], v[126:127], v[170:171]
v_pk_fma_f32 v[174:175], v[246:247], v[126:127], v[174:175] neg_lo:[0,1,0] neg_hi:[0,1,0]
v_cvt_pk_f16_f32 v144, v168, v169
v_cvt_pk_f16_f32 v146, v172, v173
v_cvt_pk_f16_f32 v145, v170, v171
v_cvt_pk_f16_f32 v147, v174, v175
v_mov_b32 v225, v8
v_mfma_f32_16x16x32_f16 v[8:11], v[140:143], v[252:255], v[8:11]
v_mfma_f32_16x16x32_f16 v[16:19], v[140:143], v[252:255], v[16:19]
v_mfma_f32_16x16x32_f16 v[12:15], v[144:147], v[252:255], v[12:15]
v_mfma_f32_16x16x32_f16 v[20:23], v[144:147], v[252:255], v[20:23]
s_nop 4
v_pk_add_f32 v[160:161], v[8:9], v[10:11]
v_pk_mul_f32 v[164:165], v[8:9], v[8:9]
v_pk_mul_f32 v[168:169], v[8:9], v[24:25]
v_pk_add_f32 v[162:163], v[16:17], v[18:19]
v_pk_mul_f32 v[166:167], v[16:17], v[16:17]
v_pk_mul_f32 v[170:171], v[16:17], v[32:33]
v_pk_fma_f32 v[164:165], v[10:11], v[10:11], v[164:165]
v_pk_fma_f32 v[168:169], v[10:11], v[26:27], v[168:169]
v_pk_fma_f32 v[166:167], v[18:19], v[18:19], v[166:167]
v_pk_fma_f32 v[170:171], v[18:19], v[34:35], v[170:171]
v_pk_add_f32 v[160:161], v[160:161], v[12:13]
v_pk_fma_f32 v[164:165], v[12:13], v[12:13], v[164:165]
v_pk_fma_f32 v[168:169], v[12:13], v[28:29], v[168:169]
v_pk_add_f32 v[162:163], v[162:163], v[20:21]
v_pk_fma_f32 v[166:167], v[20:21], v[20:21], v[166:167]
v_pk_fma_f32 v[170:171], v[20:21], v[36:37], v[170:171]
v_pk_add_f32 v[160:161], v[160:161], v[14:15]
v_pk_fma_f32 v[164:165], v[14:15], v[14:15], v[164:165]
v_pk_fma_f32 v[168:169], v[14:15], v[30:31], v[168:169]
v_pk_add_f32 v[162:163], v[162:163], v[22:23]
v_pk_fma_f32 v[166:167], v[22:23], v[22:23], v[166:167]
v_pk_fma_f32 v[170:171], v[22:23], v[38:39], v[170:171]
v_add_f32 v160, v160, v161
v_add_f32 v162, v162, v163
v_add_f32 v164, v164, v165
v_add_f32 v166, v166, v167
v_add_f32 v168, v168, v169
v_add_f32 v170, v170, v171
v_permlane32_swap_b32 v160, v162
v_permlane32_swap_b32 v164, v166
v_permlane32_swap_b32 v168, v170
v_add_f32 v218, v160, v162
v_add_f32 v219, v164, v166
v_add_f32 v220, v168, v170
v_add_f32 v221, v168, v170
v_permlane16_swap_b32 v218, v219
s_nop 0
v_permlane16_swap_b32 v220, v221
v_add_f32 v218, v218, v219
v_add_f32 v220, v220, v221
s_nop 0
v_add_f32_dpp v218, v218, v218 row_ror:8 row_mask:0xf bank_mask:0xf
v_add_f32_dpp v220, v220, v220 row_ror:8 row_mask:0xf bank_mask:0xf
s_nop 0
v_add_f32_dpp v218, v218, v218 row_ror:4 row_mask:0xf bank_mask:0xf
v_add_f32_dpp v220, v220, v220 row_ror:4 row_mask:0xf bank_mask:0xf
s_nop 0
v_add_f32_dpp v218, v218, v218 row_ror:2 row_mask:0xf bank_mask:0xf
v_add_f32_dpp v220, v220, v220 row_ror:2 row_mask:0xf bank_mask:0xf
s_nop 0
v_add_f32_dpp v219, v218, v218 row_ror:1 row_mask:0xf bank_mask:0xf
v_add_f32_dpp v218, v218, v218 row_ror:1 row_mask:0xf bank_mask:0xf
v_add_f32_dpp v220, v220, v220 row_ror:1 row_mask:0xf bank_mask:0xf
s_nop 0
v_permlane16_swap_b32 v218, v219
v_mul_f32 v194, 0x3b000000, v218
v_mul_f32 v219, 0x3b000000, v219
v_fma_f32 v219, -v194, v194, v219
v_add_f32 v218, 0x3727c5ac, v219
v_rsq_f32 v196, v218
v_fma_f32 v220, -v194, v203, v220
v_mul_f32 v220, v220, v196
v_ashrrev_i32 v150, 31, v220
v_or_b32 v150, 0x80000000, v150
v_xor_b32 v220, v220, v150
v_and_or_b32 v217, v220, v226, v216
ds_write_b32 v224, v217 offset:27136
v_mul_f32 v198, v194, v196
v_add_f32 v148, 1.0, v196
v_mul_f32 v218, v218, v196
s_waitcnt vmcnt(0)
v_mov_b32 v149, 0
s_lshl_b32 s48, s2, 4
s_add_u32 s48, s48, 5767168
s_cmp_lg_u32 s3, 0
s_waitcnt lgkmcnt(0)
s_barrier
ds_read_b128 v[152:155], v149 offset:27136
ds_read_b128 v[156:159], v149 offset:27152
ds_read_b128 v[160:163], v149 offset:27168
ds_read_b128 v[164:167], v149 offset:27184
v_mov_b32 v197, v196
v_mov_b32 v199, v198
s_lshl_b32 s49, s44, 7
v_cmp_gt_u32 s[52:53], 32, v0
v_permlane32_swap_b32 v196, v197
v_permlane32_swap_b32 v198, v199
s_waitcnt lgkmcnt(3)
v_max3_u32 v136, v152, v153, v154
v_med3_u32 v141, v152, v153, v154
s_waitcnt lgkmcnt(2)
v_max3_u32 v137, v155, v156, v157
v_med3_u32 v142, v155, v156, v157
s_waitcnt lgkmcnt(1)
v_max3_u32 v138, v158, v159, v160
v_med3_u32 v143, v158, v159, v160
v_max3_u32 v139, v161, v162, v163
v_med3_u32 v144, v161, v162, v163
s_waitcnt lgkmcnt(0)
v_max3_u32 v140, v164, v165, v166
v_med3_u32 v145, v164, v165, v166
v_max3_u32 v141, v141, v142, v143
v_med3_u32 v142, v136, v137, v138
v_max3_u32 v136, v136, v137, v138
v_med3_u32 v143, v139, v140, v167
v_max3_u32 v137, v139, v140, v167
v_max3_u32 v141, v141, v142, v143
v_min_u32 v138, v136, v137
v_max3_u32 v141, v141, v144, v145
v_max_u32 v128, v136, v137
v_max_u32 v129, v141, v138
s_mov_b64 exec, s[52:53]
buffer_store_dwordx4 v[128:131], v223, s[12:15], s48 offen sc1
s_mov_b64 exec, -1
v_cmp_ge_u32 s[52:53], v217, v129
v_cmp_eq_u32 s[54:55], v217, v129
s_cmp_eq_u32 s44, 0
s_cbranch_scc1 .L24
s_cmp_eq_u32 s3, 1
s_cselect_b64 exec, 3, 0
buffer_store_dwordx4 v[128:131], v227, s[12:15], 0 offen sc1
s_mov_b64 exec, -1
.L24:
s_lshl_b32 s50, s44, 11
s_add_u32 s50, s50, s7
s_sub_u32 s50, s50, 8448
s_bitcmp0_b32 s52, 10
s_cbranch_scc1 .L25
s_and_b32 s48, s54, 1024
s_add_u32 s48, s48, s50
v_pk_fma_f32 v[152:153], v[8:9], v[196:197], v[198:199] op_sel_hi:[1,0,0] neg_lo:[0,0,1] neg_hi:[0,0,1]
v_pk_fma_f32 v[154:155], v[10:11], v[196:197], v[198:199] op_sel_hi:[1,0,0] neg_lo:[0,0,1] neg_hi:[0,0,1]
v_pk_fma_f32 v[156:157], v[12:13], v[196:197], v[198:199] op_sel_hi:[1,0,0] neg_lo:[0,0,1] neg_hi:[0,0,1]
v_pk_fma_f32 v[158:159], v[14:15], v[196:197], v[198:199] op_sel_hi:[1,0,0] neg_lo:[0,0,1] neg_hi:[0,0,1]
v_cvt_pk_bf16_f32 v160, v152, v153
v_cvt_pk_bf16_f32 v161, v154, v155
v_cvt_pk_bf16_f32 v162, v156, v157
v_cvt_pk_bf16_f32 v163, v158, v159
buffer_store_dwordx4 v[160:163], v5, s[12:15], s48 offen sc1
.L25:
s_bitcmp0_b32 s53, 10
s_cbranch_scc1 .L26
s_and_b32 s48, s55, 1024
s_add_u32 s48, s48, s50
v_pk_fma_f32 v[152:153], v[16:17], v[196:197], v[198:199] op_sel:[0,1,1] neg_lo:[0,0,1] neg_hi:[0,0,1]
v_pk_fma_f32 v[154:155], v[18:19], v[196:197], v[198:199] op_sel:[0,1,1] neg_lo:[0,0,1] neg_hi:[0,0,1]
v_pk_fma_f32 v[156:157], v[20:21], v[196:197], v[198:199] op_sel:[0,1,1] neg_lo:[0,0,1] neg_hi:[0,0,1]
v_pk_fma_f32 v[158:159], v[22:23], v[196:197], v[198:199] op_sel:[0,1,1] neg_lo:[0,0,1] neg_hi:[0,0,1]
ds_bpermute_b32 v168, v215, v152
v_cvt_pk_bf16_f32 v165, v158, v157
v_cvt_pk_bf16_f32 v166, v156, v155
v_cvt_pk_bf16_f32 v167, v154, v153
s_waitcnt lgkmcnt(0)
v_cvt_pk_bf16_f32 v164, v168, v159
buffer_store_dwordx4 v[164:167], v6, s[12:15], s48 offen sc1
.L26:
v_sub_f32 v225, v8, v225
v_mul_f32 v149, v148, v148
v_mov_b32 v151, 0x3727c5ac
v_fma_f32 v149, v149, v219, v151
v_readfirstlane_b32 s74, v225
v_rsq_f32 v149, v149
v_add_f32 v192, 1.0, v218
v_mov_b32 v195, 0
v_mul_f32 v200, v148, v149
v_add_f32 v198, s74, v198
v_add_f32 v199, s74, v199
v_mul_f32 v193, v200, v218
v_add_f32 v196, 1.0, v196
v_add_f32 v197, 1.0, v197
s_add_u32 s49, s49, s46
s_add_u32 s49, s49, 8192
s_cmp_lg_u32 s44, 0
s_cbranch_scc1 .FIN
s_cmp_eq_u32 s3, 1
s_cselect_b64 exec, 15, 0
buffer_store_dwordx4 v[128:131], v227, s[12:15], 0 offen sc1
s_mov_b64 exec, -1
v_mul_f32 v160, v194, v200
v_mov_b32 v201, v200
v_mul_f32 v161, v194, v200
s_nop 0
v_permlane32_swap_b32 v200, v201
v_permlane32_swap_b32 v160, v161
v_add_f32 v160, v160, v161
v_pk_fma_f32 v[162:163], v[8:9], v[200:201], v[160:161] op_sel_hi:[1,0,0] neg_lo:[0,0,1] neg_hi:[0,0,1]
v_pk_fma_f32 v[164:165], v[10:11], v[200:201], v[160:161] op_sel_hi:[1,0,0] neg_lo:[0,0,1] neg_hi:[0,0,1]
v_pk_fma_f32 v[166:167], v[12:13], v[200:201], v[160:161] op_sel_hi:[1,0,0] neg_lo:[0,0,1] neg_hi:[0,0,1]
v_pk_fma_f32 v[168:169], v[14:15], v[200:201], v[160:161] op_sel_hi:[1,0,0] neg_lo:[0,0,1] neg_hi:[0,0,1]
v_pk_fma_f32 v[162:163], v[16:17], v[200:201], v[162:163] op_sel:[0,1,0]
v_pk_fma_f32 v[164:165], v[18:19], v[200:201], v[164:165] op_sel:[0,1,0]
v_pk_fma_f32 v[166:167], v[20:21], v[200:201], v[166:167] op_sel:[0,1,0]
v_pk_fma_f32 v[168:169], v[22:23], v[200:201], v[168:169] op_sel:[0,1,0]
v_cvt_pk_f16_f32 v170, v162, v163
v_cvt_pk_f16_f32 v171, v164, v165
v_cvt_pk_f16_f32 v172, v166, v167
v_cvt_pk_f16_f32 v173, v168, v169
ds_write_b16 v204, v170 offset:0
ds_write_b16_d16_hi v204, v170 offset:8
ds_write_b16 v204, v171 offset:16
ds_write_b16_d16_hi v204, v171 offset:24
ds_write_b16 v204, v172 offset:32
ds_write_b16_d16_hi v204, v172 offset:40
ds_write_b16 v204, v173 offset:48
ds_write_b16_d16_hi v204, v173 offset:56
v_subrev_f32 v194, s74, v194
s_mov_b64 exec, s[72:73]
buffer_store_dwordx4 v[192:195], v222, s[12:15], s49 offen sc1
s_mov_b64 exec, -1
v_pk_fma_f32 v[8:9], v[8:9], v[196:197], v[198:199] op_sel_hi:[1,0,0] neg_lo:[0,0,1] neg_hi:[0,0,1]
v_pk_fma_f32 v[10:11], v[10:11], v[196:197], v[198:199] op_sel_hi:[1,0,0] neg_lo:[0,0,1] neg_hi:[0,0,1]
v_pk_fma_f32 v[12:13], v[12:13], v[196:197], v[198:199] op_sel_hi:[1,0,0] neg_lo:[0,0,1] neg_hi:[0,0,1]
v_pk_fma_f32 v[14:15], v[14:15], v[196:197], v[198:199] op_sel_hi:[1,0,0] neg_lo:[0,0,1] neg_hi:[0,0,1]
v_pk_fma_f32 v[16:17], v[16:17], v[196:197], v[198:199] op_sel:[0,1,1] neg_lo:[0,0,1] neg_hi:[0,0,1]
v_pk_fma_f32 v[18:19], v[18:19], v[196:197], v[198:199] op_sel:[0,1,1] neg_lo:[0,0,1] neg_hi:[0,0,1]
v_pk_fma_f32 v[20:21], v[20:21], v[196:197], v[198:199] op_sel:[0,1,1] neg_lo:[0,0,1] neg_hi:[0,0,1]
v_pk_fma_f32 v[22:23], v[22:23], v[196:197], v[198:199] op_sel:[0,1,1] neg_lo:[0,0,1] neg_hi:[0,0,1]
s_mov_b32 s44, 1
s_not_b32 s41, s41
v_not_b32 v131, v131
v_not_b32 v135, v135
s_waitcnt lgkmcnt(0)
s_barrier
ds_read_b64 v[128:129], v205
ds_read_b64 v[132:133], v206
s_mov_b32 s48, 1056768
s_waitcnt lgkmcnt(1)
buffer_store_dwordx4 v[128:131], v207, s[12:15], 0 offen sc1
s_waitcnt lgkmcnt(0)
buffer_store_dwordx4 v[132:135], v207, s[12:15], s48 offen sc1
s_branch .TOP
.FIN:
s_cmp_eq_u32 s75, 257
s_cbranch_scc1 .L27
v_pk_fma_f32 v[152:153], v[8:9], v[196:197], v[198:199] op_sel_hi:[1,0,0] neg_lo:[0,0,1] neg_hi:[0,0,1]
v_pk_fma_f32 v[154:155], v[10:11], v[196:197], v[198:199] op_sel_hi:[1,0,0] neg_lo:[0,0,1] neg_hi:[0,0,1]
v_pk_fma_f32 v[156:157], v[12:13], v[196:197], v[198:199] op_sel_hi:[1,0,0] neg_lo:[0,0,1] neg_hi:[0,0,1]
v_pk_fma_f32 v[158:159], v[14:15], v[196:197], v[198:199] op_sel_hi:[1,0,0] neg_lo:[0,0,1] neg_hi:[0,0,1]
v_cvt_pk_bf16_f32 v160, v152, v153
v_cvt_pk_bf16_f32 v161, v154, v155
v_cvt_pk_bf16_f32 v162, v156, v157
v_cvt_pk_bf16_f32 v163, v158, v159
buffer_store_dwordx4 v[160:163], v5, s[16:19], s68 offen sc1
s_and_b32 s48, s75, 255
s_cbranch_scc0 .L27
v_pk_fma_f32 v[152:153], v[16:17], v[196:197], v[198:199] op_sel:[0,1,1] neg_lo:[0,0,1] neg_hi:[0,0,1]
v_pk_fma_f32 v[154:155], v[18:19], v[196:197], v[198:199] op_sel:[0,1,1] neg_lo:[0,0,1] neg_hi:[0,0,1]
v_pk_fma_f32 v[156:157], v[20:21], v[196:197], v[198:199] op_sel:[0,1,1] neg_lo:[0,0,1] neg_hi:[0,0,1]
v_pk_fma_f32 v[158:159], v[22:23], v[196:197], v[198:199] op_sel:[0,1,1] neg_lo:[0,0,1] neg_hi:[0,0,1]
ds_bpermute_b32 v168, v215, v152
v_cvt_pk_bf16_f32 v165, v158, v157
v_cvt_pk_bf16_f32 v166, v156, v155
v_cvt_pk_bf16_f32 v167, v154, v153
s_waitcnt lgkmcnt(0)
v_cvt_pk_bf16_f32 v164, v168, v159
buffer_store_dwordx4 v[164:167], v6, s[16:19], s69 offen sc1
.L27:
s_waitcnt vmcnt(0)
v_subrev_f32 v194, s74, v194
s_mov_b64 exec, s[72:73]
buffer_store_dwordx4 v[192:195], v222, s[12:15], s49 offen sc1
s_mov_b64 exec, -1
s_or_b32 s48, s2, s3
s_cbranch_scc1 .L28
s_add_u32 s42, s42, 1
s_mov_b64 exec, 1
v_mov_b32 v136, s42
v_mov_b32 v137, 2113536
buffer_store_dword v136, v137, s[12:15], 0 offen sc1
.L28:
s_endpgm
.FFN:
s_sub_u32 s74, s2, 129
s_and_b32 s48, s74, 7
s_lshr_b32 s49, s74, 3
s_mul_i32 s70, s48, 14
s_add_u32 s70, s70, s49
s_lshl_b32 s68, s48, 3
s_add_u32 s68, s68, s49
s_mul_i32 s48, s43, 458752
s_lshl_b32 s49, s70, 5
s_add_u32 s48, s48, s49
v_lshrrev_b32 v148, 1, v1
v_mul_u32_u24 v148, 3584, v148
v_and_b32 v153, 1, v0
v_lshl_add_u32 v148, v153, 4, v148
v_add_u32 v148, s48, v148
v_lshlrev_b32 v157, 10, v3
v_lshl_add_u32 v157, v2, 4, v157
s_lshl_b32 s48, s70, 14
s_lshl_b32 s49, s43, 8
s_add_u32 s48, s48, s49
v_add_u32 v157, s48, v157
s_add_u32 s60, s70, 0
s_and_b32 s60, s60, 3
s_mul_i32 s64, s60, 114688
s_lshl_b32 s60, s60, 10
s_add_u32 s61, s70, 1
s_and_b32 s61, s61, 3
s_mul_i32 s65, s61, 114688
s_lshl_b32 s61, s61, 10
s_add_u32 s62, s70, 2
s_and_b32 s62, s62, 3
s_mul_i32 s66, s62, 114688
s_lshl_b32 s62, s62, 10
s_add_u32 s63, s70, 3
s_and_b32 s63, s63, 3
s_mul_i32 s67, s63, 114688
s_lshl_b32 s63, s63, 10
s_waitcnt lgkmcnt(0)
buffer_load_dwordx4 v[64:67], v148, s[28:31], s64 offen
s_waitcnt vmcnt(0)
buffer_load_dwordx4 v[80:83], v148, s[32:35], s64 offen
s_waitcnt vmcnt(0)
s_mov_b32 s48, 0
buffer_load_dwordx4 v[96:99], v157, s[36:39], s48 offen
s_mov_b32 s48, 4096
buffer_load_dwordx4 v[100:103], v157, s[36:39], s48 offen
s_waitcnt vmcnt(0)
s_mov_b32 s48, 8192
buffer_load_dwordx4 v[104:107], v157, s[36:39], s48 offen
s_mov_b32 s48, 12288
buffer_load_dwordx4 v[108:111], v157, s[36:39], s48 offen
s_waitcnt vmcnt(0)
buffer_load_dwordx4 v[68:71], v148, s[28:31], s65 offen
buffer_load_dwordx4 v[84:87], v148, s[32:35], s65 offen
buffer_load_dwordx4 v[72:75], v148, s[28:31], s66 offen
buffer_load_dwordx4 v[88:91], v148, s[32:35], s66 offen
buffer_load_dwordx4 v[76:79], v148, s[28:31], s67 offen
buffer_load_dwordx4 v[92:95], v148, s[32:35], s67 offen
s_and_b32 s69, s74, 31
s_mul_i32 s69, s69, 4352
s_add_u32 s69, s69, 5767168
v_lshlrev_b32 v149, 4, v0
buffer_load_dword v112, v149, s[12:15], s69 offen sc1
buffer_load_dword v113, v149, s[12:15], s69 offen offset:64 sc1
v_lshlrev_b32 v149, 4, v1
v_lshlrev_b32 v150, 4, v3
s_lshl_b32 s48, s43, 8
v_add_u32 v150, s48, v150
s_lshl_b32 s48, s43, 4
v_lshrrev_b32 v153, 2, v2
v_lshl_add_u32 v153, v3, 2, v153
v_add_u32 v153, s48, v153
v_lshrrev_b32 v153, 1, v153
v_mul_u32_u24 v151, 16896, v153
v_lshrrev_b32 v163, 1, v1
v_lshlrev_b32 v163, 6, v163
v_and_b32 v153, 7, v0
v_lshl_add_u32 v151, v153, 3, v151
v_and_b32 v153, 1, v0
v_lshl_add_u32 v163, v153, 4, v163
v_mov_b32 v152, 0
s_lshl_b32 s48, s43, 3
v_lshl_add_u32 v155, v2, 5, s48
v_and_b32 v154, 31, v0
v_lshlrev_b32 v156, 5, v154
s_lshl_b32 s48, s43, 6
v_lshl_add_u32 v158, v154, 1, s48
v_lshlrev_b32 v159, 1, v1
v_lshrrev_b32 v160, 3, v1
v_lshlrev_b32 v160, 12, v160
v_and_b32 v161, 7, v0
v_lshl_add_u32 v160, v161, 3, v160
v_lshrrev_b32 v161, 1, v1
v_mul_u32_u24 v161, 112, v161
v_add_u32 v161, s74, v161
v_cmp_gt_u32 vcc, 129, v161
s_mov_b64 s[72:73], vcc
v_mul_u32_u24 v161, 17920, v161
v_lshl_add_u32 v161, v153, 4, v161
v_lshrrev_b32 v162, 1, v1
s_and_b32 s48, s74, 127
v_lshl_add_u32 v162, v162, 6, s48
v_cmp_gt_u32 vcc, 129, v162
s_mov_b64 s[6:7], vcc
v_mul_u32_u24 v162, 17920, v162
v_lshl_add_u32 v162, v153, 4, v162
v_and_b32 v153, 1, v3
s_lshl_b32 s68, s74, 4
v_bfe_u32 v114, v0, 1, 1
v_lshlrev_b32 v114, 5, v114
v_lshl_add_u32 v114, v153, 4, v114
s_lshl_b32 s48, s43, 6
s_add_u32 s48, s48, 2048
v_add_u32 v114, s48, v114
v_mov_b32 v115, 2304
v_lshrrev_b32 v116, 1, v3
v_and_b32 v117, 13, v0
v_and_b32 v118, 1, v0
v_lshlrev_b32 v118, 4, v118
v_mov_b32 v120, 0x3c00
v_lshlrev_b32 v118, v118, v120
v_bfe_u32 v119, v0, 1, 2
v_mov_b32 v122, 0
v_mov_b32 v123, 0
ds_write_b64 v115, v[122:123]
ds_write_b64 v115, v[122:123] offset:8
v_add_u32 v120, 0, v116
v_cmp_eq_u32 vcc, v120, v117
s_nop 1
v_cndmask_b32 v60, v115, v114, vcc
v_cmp_eq_u32 vcc, 0, v119
s_nop 1
v_cndmask_b32 v56, 0, v118, vcc
v_add_u32 v120, 4, v116
v_cmp_eq_u32 vcc, v120, v117
s_nop 1
v_cndmask_b32 v61, v115, v114, vcc
v_cmp_eq_u32 vcc, 1, v119
s_nop 1
v_cndmask_b32 v57, 0, v118, vcc
v_add_u32 v120, 8, v116
v_cmp_eq_u32 vcc, v120, v117
s_nop 1
v_cndmask_b32 v62, v115, v114, vcc
v_cmp_eq_u32 vcc, 2, v119
s_nop 1
v_cndmask_b32 v58, 0, v118, vcc
v_add_u32 v120, 12, v116
v_cmp_eq_u32 vcc, v120, v117
s_nop 1
v_cndmask_b32 v63, v115, v114, vcc
v_cmp_eq_u32 vcc, 3, v119
s_nop 1
v_cndmask_b32 v59, 0, v118, vcc
s_lshl_b32 s48, s43, 12
s_add_u32 s48, s48, 4096
v_lshl_add_u32 v114, v1, 4, s48
v_lshl_add_u32 v115, v2, 3, s48
v_lshl_add_u32 v115, v3, 8, v115
v_lshrrev_b32 v117, 2, v2
v_lshl_add_u32 v117, v153, 3, v117
v_lshl_add_u32 v117, v117, 8, s48
v_and_b32 v118, 3, v0
v_lshl_add_u32 v117, v118, 6, v117
v_lshl_add_u32 v117, v116, 3, v117
s_waitcnt vmcnt(0) lgkmcnt(0)
v_add_u32 v119, s60, v114
ds_write_b128 v119, v[64:67]
v_add_u32 v119, s61, v114
ds_write_b128 v119, v[68:71]
v_add_u32 v119, s62, v114
ds_write_b128 v119, v[72:75]
v_add_u32 v119, s63, v114
ds_write_b128 v119, v[76:79]
ds_read_b64_tr_b16 v[8:9], v115 offset:0
ds_read_b64_tr_b16 v[10:11], v115 offset:128
ds_read_b64_tr_b16 v[12:13], v115 offset:1024
ds_read_b64_tr_b16 v[14:15], v115 offset:1152
ds_read_b64_tr_b16 v[16:17], v115 offset:2048
ds_read_b64_tr_b16 v[18:19], v115 offset:2176
ds_read_b64_tr_b16 v[20:21], v115 offset:3072
ds_read_b64_tr_b16 v[22:23], v115 offset:3200
s_waitcnt vmcnt(0) lgkmcnt(0)
v_add_u32 v119, s60, v114
ds_write_b128 v119, v[80:83]
v_add_u32 v119, s61, v114
ds_write_b128 v119, v[84:87]
v_add_u32 v119, s62, v114
ds_write_b128 v119, v[88:91]
v_add_u32 v119, s63, v114
ds_write_b128 v119, v[92:95]
ds_read_b64_tr_b16 v[24:25], v115 offset:0
ds_read_b64_tr_b16 v[26:27], v115 offset:128
ds_read_b64_tr_b16 v[28:29], v115 offset:1024
ds_read_b64_tr_b16 v[30:31], v115 offset:1152
ds_read_b64_tr_b16 v[32:33], v115 offset:2048
ds_read_b64_tr_b16 v[34:35], v115 offset:2176
ds_read_b64_tr_b16 v[36:37], v115 offset:3072
ds_read_b64_tr_b16 v[38:39], v115 offset:3200
s_waitcnt vmcnt(0) lgkmcnt(0)
ds_write_b128 v114, v[96:99] offset:0
ds_write_b128 v114, v[100:103] offset:1024
ds_write_b128 v114, v[104:107] offset:2048
ds_write_b128 v114, v[108:111] offset:3072
ds_read_b64_tr_b16 v[40:41], v117 offset:0
ds_read_b64_tr_b16 v[42:43], v117 offset:1024
ds_read_b64_tr_b16 v[44:45], v117 offset:16
ds_read_b64_tr_b16 v[46:47], v117 offset:1040
ds_read_b64_tr_b16 v[48:49], v117 offset:32
ds_read_b64_tr_b16 v[50:51], v117 offset:1056
ds_read_b64_tr_b16 v[52:53], v117 offset:48
ds_read_b64_tr_b16 v[54:55], v117 offset:1072
s_waitcnt lgkmcnt(0)
s_mul_i32 s40, s42, 0x9E3779B1
s_add_u32 s40, s40, 0x7F4A7C15
s_xor_b32 s41, s42, 0x5bd1e995
s_mul_i32 s41, s41, 0x85EBCA6B
s_lshl_b32 s47, s74, 8
s_add_u32 s47, s47, 2129920
.FTOP:
.L29:
buffer_load_dwordx2 v[64:65], v152, s[12:15], s47 offen offset:8 sc1
s_waitcnt vmcnt(0)
v_cmp_ne_u64 vcc, v[64:65], s[40:41]
s_cbranch_vccz .L30
s_mov_b64 exec, vcc
s_sleep 4
s_sub_i32 s45, s45, 1
s_cmp_gt_i32 s45, 0
s_cbranch_scc1 .L29
.L30:
s_mov_b64 exec, -1
s_mov_b32 s48, s69
s_add_u32 s49, s48, 2048
s_mov_b64 s[54:55], 1
v_mov_b32 v64, 0
v_mov_b32 v65, 0
v_mov_b32 v66, s40
v_mov_b32 v67, s41
.L31:
buffer_load_dwordx4 v[72:75], v149, s[12:15], s48 offen sc1
buffer_load_dwordx4 v[76:79], v149, s[12:15], s48 offen offset:1024 sc1
s_and_saveexec_b64 s[52:53], s[54:55]
buffer_load_dwordx4 v[64:67], v152, s[12:15], s49 offen sc1
s_mov_b64 exec, s[52:53]
s_waitcnt vmcnt(0)
v_cmp_ne_u64 vcc, v[74:75], s[40:41]
v_cmp_ne_u64 s[52:53], v[66:67], s[40:41]
v_cmp_ne_u64 s[56:57], v[78:79], s[40:41]
s_or_b64 vcc, vcc, s[52:53]
s_or_b64 vcc, vcc, s[56:57]
s_cbranch_vccz .L32
s_mov_b64 exec, vcc
s_sleep 1
s_sub_i32 s45, s45, 1
s_cmp_gt_i32 s45, 0
s_cbranch_scc1 .L31
.L32:
s_mov_b64 exec, -1
v_not_b32 v75, v75
v_med3_u32 v70, v72, v64, v76
v_max3_u32 v73, v73, v65, v77
v_max3_u32 v72, v72, v64, v76
v_max_u32 v73, v73, v70
s_nop 0
v_min_u32_dpp v70, v72, v72 row_ror:8 row_mask:0xf bank_mask:0xf
v_max_u32_dpp v71, v73, v73 row_ror:8 row_mask:0xf bank_mask:0xf
v_max_u32_dpp v72, v72, v72 row_ror:8 row_mask:0xf bank_mask:0xf
v_max_u32 v73, v70, v71
s_nop 0
v_min_u32_dpp v70, v72, v72 row_ror:4 row_mask:0xf bank_mask:0xf
v_max_u32_dpp v71, v73, v73 row_ror:4 row_mask:0xf bank_mask:0xf
v_max_u32_dpp v72, v72, v72 row_ror:4 row_mask:0xf bank_mask:0xf
v_max_u32 v73, v70, v71
s_nop 0
v_min_u32_dpp v70, v72, v72 row_ror:2 row_mask:0xf bank_mask:0xf
v_max_u32_dpp v71, v73, v73 row_ror:2 row_mask:0xf bank_mask:0xf
v_max_u32_dpp v72, v72, v72 row_ror:2 row_mask:0xf bank_mask:0xf
v_max_u32 v73, v70, v71
s_nop 0
v_min_u32_dpp v70, v72, v72 row_ror:1 row_mask:0xf bank_mask:0xf
v_max_u32_dpp v71, v73, v73 row_ror:1 row_mask:0xf bank_mask:0xf
v_max_u32_dpp v72, v72, v72 row_ror:1 row_mask:0xf bank_mask:0xf
v_max_u32 v73, v70, v71
v_mov_b32 v70, v72
v_mov_b32 v71, v73
s_nop 0
v_permlane16_swap_b32 v72, v70
v_permlane16_swap_b32 v73, v71
v_min_u32 v64, v72, v70
v_max_u32 v72, v72, v70
v_max3_u32 v73, v73, v71, v64
v_mov_b32 v70, v72
v_mov_b32 v71, v73
s_nop 0
v_permlane32_swap_b32 v72, v70
v_permlane32_swap_b32 v73, v71
v_min_u32 v64, v72, v70
v_max_u32 v72, v72, v70
v_max3_u32 v73, v73, v71, v64
v_readfirstlane_b32 s58, v72
v_readfirstlane_b32 s59, v73
v_and_b32 v70, 1, v0
s_lshl_b32 s50, s44, 11
s_add_u32 s50, s50, 3407872
s_bfe_u32 s48, s58, 0x80004
s_bfe_u32 s49, s59, 0x80004
s_cmp_eq_u32 s48, s49
s_cselect_b32 s51, 1024, 0
s_mul_i32 s60, s48, 17920
s_mul_i32 s61, s49, 17920
s_add_u32 s60, s60, s50
s_add_u32 s61, s61, s50
s_add_u32 s61, s61, s51
s_sub_u32 s51, s61, s60
v_mul_lo_u32 v70, v70, s51
v_add3_u32 v71, v70, v150, s60
s_lshl_b32 s50, s44, 2
s_add_u32 s50, s50, s43
s_cmp_lg_u32 s50, 1
s_cbranch_scc1 .L34
buffer_load_dwordx4 v[80:83], v71, s[12:15], 0 offen sc1
buffer_load_dwordx4 v[84:87], v71, s[12:15], 0 offen offset:64 sc1
buffer_load_dwordx4 v[88:91], v71, s[12:15], 0 offen offset:128 sc1
buffer_load_dwordx4 v[92:95], v71, s[12:15], 0 offen offset:192 sc1
s_mov_b32 s50, 3416320
s_mov_b64 exec, s[72:73]
buffer_store_dwordx4 v[72:75], v161, s[12:15], s50 offen sc1
s_mov_b64 exec, -1
s_waitcnt vmcnt(1)
s_branch .L33
.L34:
buffer_load_dwordx4 v[80:83], v71, s[12:15], 0 offen sc1
buffer_load_dwordx4 v[84:87], v71, s[12:15], 0 offen offset:64 sc1
buffer_load_dwordx4 v[88:91], v71, s[12:15], 0 offen offset:128 sc1
buffer_load_dwordx4 v[92:95], v71, s[12:15], 0 offen offset:192 sc1
s_waitcnt vmcnt(0)
.L33:
v_max3_u32 v64, v80, v81, v82
v_max3_u32 v64, v64, v83, v84
v_max3_u32 v64, v64, v85, v86
v_max3_u32 v64, v64, v87, v88
v_max3_u32 v64, v64, v89, v90
v_max3_u32 v64, v64, v91, v92
v_max3_u32 v64, v64, v93, v94
v_max_u32 v64, v64, v95
v_cmp_eq_u32 vcc, -1, v64
s_cbranch_vccz .L35
s_mov_b64 exec, vcc
s_sub_i32 s45, s45, 1
s_cmp_gt_i32 s45, 0
s_cbranch_scc1 .L34
.L35:
s_mov_b64 exec, -1
v_mfma_f32_16x16x32_bf16 v[128:131], v[80:83], v[8:11], 0
v_mfma_f32_16x16x32_bf16 v[132:135], v[80:83], v[24:27], 0
v_mfma_f32_16x16x32_bf16 v[128:131], v[84:87], v[12:15], v[128:131]
v_mfma_f32_16x16x32_bf16 v[132:135], v[84:87], v[28:31], v[132:135]
v_mfma_f32_16x16x32_bf16 v[128:131], v[88:91], v[16:19], v[128:131]
v_mfma_f32_16x16x32_bf16 v[132:135], v[88:91], v[32:35], v[132:135]
v_mfma_f32_16x16x32_bf16 v[128:131], v[92:95], v[20:23], v[128:131]
v_mfma_f32_16x16x32_bf16 v[132:135], v[92:95], v[36:39], v[132:135]
s_bfe_u32 s48, s58, 0x90003
s_mul_i32 s62, s48, 8960
s_and_b32 s50, s58, 7
s_lshl_b32 s50, s50, 4
s_add_u32 s62, s62, s50
s_bfe_u32 s50, s58, 0x20001
s_lshl_b32 s50, s50, 9
s_add_u32 s64, s50, s48
s_sub_u32 s50, 2048, s64
s_bitcmp1_b32 s58, 0
s_cselect_b32 s64, s50, s64
s_and_b32 s64, s64, 2047
s_bfe_u32 s49, s59, 0x90003
s_mul_i32 s63, s49, 8960
s_and_b32 s50, s59, 7
s_lshl_b32 s50, s50, 4
s_add_u32 s63, s63, s50
s_bfe_u32 s50, s59, 0x20001
s_lshl_b32 s50, s50, 9
s_add_u32 s65, s50, s49
s_sub_u32 s50, 2048, s65
s_bitcmp1_b32 s59, 0
s_cselect_b32 s65, s50, s65
s_and_b32 s65, s65, 2047
s_mov_b64 exec, 0xffff
ds_write2_b32 v155, v128, v132 offset0:64 offset1:65
ds_write2_b32 v155, v129, v133 offset0:192 offset1:193
s_mov_b64 exec, -1
s_mul_i32 s51, s44, 8448
s_add_u32 s51, s51, 6356992
s_waitcnt lgkmcnt(0)
s_barrier
ds_read_b128 v[64:67], v156 offset:256
ds_read_b128 v[68:71], v156 offset:272
s_lshl_b32 s50, s74, 6
s_add_u32 s50, s50, s51
s_waitcnt lgkmcnt(0)
v_pk_add_f32 v[64:65], v[64:65], v[66:67]
v_pk_add_f32 v[68:69], v[68:69], v[70:71]
v_pk_add_f32 v[64:65], v[64:65], v[68:69]
v_mul_f32 v66, 0xbfb8aa3b, v64
v_exp_f32 v66, v66
v_mul_f32 v64, v64, v65
v_add_f32 v66, 1.0, v66
v_rcp_f32 v66, v66
s_nop 0
v_mul_f32 v64, v64, v66
v_cvt_pk_bf16_f32 v64, v64, v64
ds_write_b16 v158, v64 offset:2048
ds_read_b128 v[80:83], v60
ds_read_b128 v[84:87], v61
ds_read_b128 v[88:91], v62
ds_read_b128 v[92:95], v63
s_waitcnt lgkmcnt(3)
v_mfma_f32_16x16x32_bf16 v[128:131], v[40:43], v[80:83], 0
s_waitcnt lgkmcnt(2)
v_mfma_f32_16x16x32_bf16 v[128:131], v[44:47], v[84:87], v[128:131]
s_waitcnt lgkmcnt(1)
v_mfma_f32_16x16x32_bf16 v[128:131], v[48:51], v[88:91], v[128:131]
s_waitcnt lgkmcnt(0)
v_mfma_f32_16x16x32_bf16 v[128:131], v[52:55], v[92:95], v[128:131]
s_nop 7
v_cvt_pk_f16_f32 v64, v128, v129
v_cvt_pk_f16_f32 v65, v130, v131
buffer_store_dwordx2 v[64:65], v151, s[12:15], s50 offen sc1
s_cmp_ge_u32 s74, 64
s_cbranch_scc1 .FNEXT
s_cmp_lg_u32 s43, 0
s_cbranch_scc1 .FNEXT
s_lshl_b32 s50, s44, 7
s_add_u32 s50, s50, 3416064
s_add_u32 s62, s62, s50
s_add_u32 s63, s63, s50
s_add_u32 s60, s60, s68
s_add_u32 s61, s61, s68
v_and_b32 v76, 14, v159
.L36:
buffer_load_dwordx4 v[136:139], v152, s[12:15], s62 offen sc1
buffer_load_dwordx4 v[140:143], v152, s[12:15], s63 offen sc1
buffer_load_ushort v144, v76, s[12:15], s60 offen sc1
buffer_load_ushort v145, v76, s[12:15], s61 offen sc1
v_and_b32 v64, 0xfffff000, v72
v_not_b32 v66, v64
v_ashrrev_i32 v66, 31, v66
v_or_b32 v66, 0x80000000, v66
v_xor_b32 v64, v64, v66
v_mul_f32 v64, 0xbfb8aa3b, v64
v_exp_f32 v64, v64
s_nop 0
v_add_f32 v64, 1.0, v64
v_rcp_f32 v146, v64
v_and_b32 v65, 0xfffff000, v73
v_not_b32 v66, v65
v_ashrrev_i32 v66, 31, v66
v_or_b32 v66, 0x80000000, v66
v_xor_b32 v65, v65, v66
v_mul_f32 v65, 0xbfb8aa3b, v65
v_exp_f32 v65, v65
s_nop 0
v_add_f32 v65, 1.0, v65
v_rcp_f32 v147, v65
s_waitcnt vmcnt(0)
v_max3_u32 v64, v136, v137, v138
v_max3_u32 v64, v64, v139, v140
v_max3_u32 v64, v64, v141, v142
v_max_u32 v64, v64, v143
v_cmp_eq_u32 vcc, -1, v64
s_cbranch_vccz .L37
s_mov_b64 exec, vcc
s_sleep 1
s_sub_i32 s45, s45, 1
s_cmp_gt_i32 s45, 0
s_cbranch_scc1 .L36
.L37:
s_mov_b64 exec, -1
v_lshlrev_b32 v144, 16, v144
v_lshlrev_b32 v145, 16, v145
s_lshr_b32 s50, s74, 1
s_mul_i32 s50, s50, 16896
s_add_u32 s50, s50, s51
s_and_b32 s51, s74, 1
s_lshl_b32 s51, s51, 5
s_add_u32 s50, s50, s51
s_add_u32 s51, s50, 4096
v_mul_f32 v72, v144, v136
v_mul_f32 v73, v145, v140
v_mov_b32 v92, 0
v_mov_b32 v93, 0
v_mov_b32 v94, 0
v_mov_b32 v95, 0
.L38:
buffer_load_dwordx4 v[80:83], v163, s[12:15], s50 offen sc1
buffer_load_dwordx4 v[84:87], v163, s[12:15], s50 offen offset:2048 sc1
buffer_load_dwordx4 v[88:91], v163, s[12:15], s51 offen sc1
s_mov_b32 s48, exec_hi
s_mov_b32 exec_hi, 0
buffer_load_dwordx4 v[92:95], v163, s[12:15], s51 offen offset:2048 sc1
s_mov_b32 exec_hi, s48
s_waitcnt vmcnt(0)
v_max3_u32 v64, v80, v81, v82
v_max3_u32 v64, v64, v83, v84
v_max3_u32 v64, v64, v85, v86
v_max3_u32 v64, v64, v87, v88
v_max3_u32 v64, v64, v89, v90
v_max3_u32 v64, v64, v91, v92
v_max3_u32 v64, v64, v93, v94
v_max_u32 v64, v64, v95
v_cmp_eq_u32 vcc, -1, v64
s_cbranch_vccz .L39
s_mov_b64 exec, vcc
s_sub_i32 s45, s45, 1
s_cmp_gt_i32 s45, 0
s_cbranch_scc1 .L38
.L39:
s_mov_b64 exec, -1
s_mov_b32 s48, 3416448
s_cmp_eq_u32 s44, 0
s_cselect_b64 exec, s[6:7], 0
buffer_store_dwordx4 v[72:75], v162, s[12:15], s48 offen sc1
s_mov_b64 exec, -1
v_mfma_f32_16x16x32_f16 v[128:131], v[80:83], v[56:59], 0
v_mfma_f32_16x16x32_f16 v[128:131], v[84:87], v[56:59], v[128:131]
v_mfma_f32_16x16x32_f16 v[128:131], v[88:91], v[56:59], v[128:131]
v_mfma_f32_16x16x32_f16 v[128:131], v[92:95], v[56:59], v[128:131]
s_nop 7
v_pk_add_f32 v[64:65], v[128:129], v[130:131]
s_nop 1
v_permlane32_swap_b32 v64, v65
v_add_f32 v66, v64, v65
v_add_f32 v67, v64, v65
s_nop 1
v_permlane16_swap_b32 v66, v67
v_add_f32 v64, v66, v67
v_add_f32 v65, v66, v67
s_nop 1
v_permlane32_swap_b32 v64, v65
v_pk_fma_f32 v[64:65], v[64:65], v[146:147], v[72:73]
s_cmp_lg_u32 s44, 0
s_cbranch_scc1 .L40
v_mul_f32 v66, v144, v137
v_mul_f32 v67, v145, v141
v_mul_f32 v64, 0x3e800000, v64
v_mul_f32 v65, 0x3e800000, v65
s_lshl_b32 s50, s68, 2
s_add_u32 s50, s50, 6160384
v_cvt_pk_f16_f32 v64, v64, v66
v_cvt_pk_f16_f32 v65, v65, v67
buffer_store_dwordx2 v[64:65], v160, s[12:15], s50 offen sc1
s_add_u32 s50, s50, 0x8000
buffer_store_dwordx2 v[64:65], v160, s[12:15], s50 offen sc1
s_add_u32 s50, s50, 0x8000
s_branch .FNEXT
.L40:
v_add_f32 v64, v64, v138
v_add_f32 v65, v65, v142
s_lshl_b32 s64, s64, 10
s_lshl_b32 s65, s65, 10
s_add_u32 s64, s64, s68
s_add_u32 s65, s65, s68
v_cvt_pk_bf16_f32 v64, v64, v64
v_cvt_pk_bf16_f32 v65, v65, v65
s_mov_b64 exec, 0xff
buffer_store_short v64, v159, s[16:19], s64 offen sc1
buffer_store_short v65, v159, s[16:19], s65 offen sc1
s_mov_b64 exec, -1
.FNEXT:
s_not_b32 s41, s41
s_add_u32 s44, s44, 1
s_cmp_eq_u32 s44, 1
s_cbranch_scc1 .FTOP
s_endpgm
.END:
s_endpgm
.section .rodata,"a"
.p2align 8
ftabs:
.long 0x3c003c00,0x3c003c00,0x3c003c00,0x3c003c00,0x3c00,0x8000bc00,0xb9a839a8,0x39a8b9a8
.long 0xbc003c00,0xbc003c00,0x8000,0x8000,0x80003c00,0xbc00,0x39a8b9a8,0xb9a839a8
.long 0x3c003c00,0x3c003c00,0xbc00bc00,0xbc00bc00,0x3c00,0x8000bc00,0x39a8b9a8,0xb9a839a8
.long 0xbc003c00,0xbc003c00,0x80000000,0x80000000,0x80003c00,0xbc00,0xb9a839a8,0x39a8b9a8
.long 0x3c003c00,0x3c003c00,0x3c003c00,0x3c003c00,0x3c00,0x8000bc00,0xb9a839a8,0x39a8b9a8
.long 0xbc003c00,0xbc003c00,0x8000,0x8000,0x80003c00,0xbc00,0x39a8b9a8,0xb9a839a8
.long 0x3c003c00,0x3c003c00,0xbc00bc00,0xbc00bc00,0x3c00,0x8000bc00,0x39a8b9a8,0xb9a839a8
.long 0xbc003c00,0xbc003c00,0x80000000,0x80000000,0x80003c00,0xbc00,0xb9a839a8,0x39a8b9a8
.long 0x3c003c00,0x3c003c00,0x3c003c00,0x3c003c00,0xb23e3bd9,0x323ebbd9,0xb8723aa7,0x3872baa7
.long 0xbb643b64,0xbb643b64,0xb61f361f,0xb61f361f,0x38723aa7,0xb872baa7,0x3bd9b23e,0xbbd9323e
.long 0x39a839a8,0x39a839a8,0xb9a8b9a8,0xb9a8b9a8,0xbaa73872,0x3aa7b872,0xb23ebbd9,0x323e3bd9
.long 0xb61f361f,0xb61f361f,0x3b64bb64,0x3b64bb64,0x3bd9323e,0xbbd9b23e,0xbaa7b872,0x3aa73872
.long 0x0,0x0,0x0,0x0,0xbbd9b23e,0x3bd9323e,0x3aa73872,0xbaa7b872
.long 0x361fb61f,0x361fb61f,0xbb643b64,0xbb643b64,0x3aa7b872,0xbaa73872,0x323e3bd9,0xb23ebbd9
.long 0xb9a8b9a8,0xb9a8b9a8,0x39a839a8,0x39a839a8,0xb872baa7,0x38723aa7,0xbbd9323e,0x3bd9b23e
.long 0x3b64bb64,0x3b64bb64,0x361fb61f,0x361fb61f,0x323ebbd9,0xb23e3bd9,0x3872baa7,0xb8723aa7
.long 0x3c003c00,0x3c003c00,0x3c003c00,0x3c003c00,0xb61f3b64,0x361fbb64,0xb61f3b64,0x361fbb64
.long 0xb9a839a8,0xb9a839a8,0xb9a839a8,0xb9a839a8,0x3b64361f,0xbb64b61f,0x3b64361f,0xbb64b61f
.long 0x0,0x0,0x80008000,0x80008000,0xbb64b61f,0x3b64361f,0xbb64b61f,0x3b64361f
.long 0x39a8b9a8,0x39a8b9a8,0x39a8b9a8,0x39a8b9a8,0x361fbb64,0xb61f3b64,0x361fbb64,0xb61f3b64
.long 0xbc00bc00,0xbc00bc00,0xbc00bc00,0xbc00bc00,0x361fbb64,0xb61f3b64,0x361fbb64,0xb61f3b64
.long 0x39a8b9a8,0x39a8b9a8,0x39a8b9a8,0x39a8b9a8,0xbb64b61f,0x3b64361f,0xbb64b61f,0x3b64361f
.long 0x80008000,0x80008000,0x0,0x0,0x3b64361f,0xbb64b61f,0x3b64361f,0xbb64b61f
.long 0xb9a839a8,0xb9a839a8,0xb9a839a8,0xb9a839a8,0xb61f3b64,0x361fbb64,0xb61f3b64,0x361fbb64
.long 0x3c003c00,0x3c003c00,0x3c003c00,0x3c003c00,0xb8723aa7,0x3872baa7,0xb23e3bd9,0x323ebbd9
.long 0xb61f361f,0xb61f361f,0xbb643b64,0xbb643b64,0x3bd9b23e,0xbbd9323e,0x38723aa7,0xb872baa7
.long 0xb9a8b9a8,0xb9a8b9a8,0x39a839a8,0x39a839a8,0xb23ebbd9,0x323e3bd9,0xbaa73872,0x3aa7b872
.long 0x3b64bb64,0x3b64bb64,0xb61f361f,0xb61f361f,0xbaa7b872,0x3aa73872,0x3bd9323e,0xbbd9b23e
.long 0x80008000,0x80008000,0x80008000,0x80008000,0x3aa73872,0xbaa7b872,0xbbd9b23e,0x3bd9323e
.long 0xbb643b64,0xbb643b64,0x361fb61f,0x361fb61f,0x323e3bd9,0xb23ebbd9,0x3aa7b872,0xbaa73872
.long 0x39a839a8,0x39a839a8,0xb9a8b9a8,0xb9a8b9a8,0xbbd9323e,0x3bd9b23e,0xb872baa7,0x38723aa7
.long 0x361fb61f,0x361fb61f,0x3b64bb64,0x3b64bb64,0x3872baa7,0xb8723aa7,0x323ebbd9,0xb23e3bd9
.long 0x80008000,0x80008000,0x80008000,0x80008000,0xbc008000,0x3c008000,0x39a839a8,0xb9a8b9a8
.long 0x80008000,0x80008000,0xbc003c00,0xbc003c00,0x3c008000,0xbc008000,0x39a839a8,0xb9a8b9a8
.long 0x80008000,0x80008000,0x80008000,0x80008000,0xbc008000,0x3c008000,0xb9a8b9a8,0x39a839a8
.long 0x80008000,0x80008000,0x3c00bc00,0x3c00bc00,0x3c008000,0xbc008000,0xb9a8b9a8,0x39a839a8
.long 0x80008000,0x80008000,0x80008000,0x80008000,0xbc008000,0x3c008000,0x39a839a8,0xb9a8b9a8
.long 0x80008000,0x80008000,0xbc003c00,0xbc003c00,0x3c008000,0xbc008000,0x39a839a8,0xb9a8b9a8
.long 0x80008000,0x80008000,0x80008000,0x80008000,0xbc008000,0x3c008000,0xb9a8b9a8,0x39a839a8
.long 0x80008000,0x80008000,0x3c00bc00,0x3c00bc00,0x3c008000,0xbc008000,0xb9a8b9a8,0x39a839a8
.long 0x80008000,0x80008000,0x80008000,0x80008000,0xbbd9b23e,0x3bd9323e,0x3aa73872,0xbaa7b872
.long 0x361fb61f,0x361fb61f,0xbb643b64,0xbb643b64,0x3aa7b872,0xbaa73872,0x323e3bd9,0xb23ebbd9
.long 0xb9a8b9a8,0xb9a8b9a8,0x39a839a8,0x39a839a8,0xb872baa7,0x38723aa7,0xbbd9323e,0x3bd9b23e
.long 0x3b64bb64,0x3b64bb64,0x361fb61f,0x361fb61f,0x323ebbd9,0xb23e3bd9,0x3872baa7,0xb8723aa7
.long 0xbc00bc00,0xbc00bc00,0xbc00bc00,0xbc00bc00,0x323ebbd9,0xb23e3bd9,0x3872baa7,0xb8723aa7
.long 0x3b64bb64,0x3b64bb64,0x361fb61f,0x361fb61f,0xb872baa7,0x38723aa7,0xbbd9323e,0x3bd9b23e
.long 0xb9a8b9a8,0xb9a8b9a8,0x39a839a8,0x39a839a8,0x3aa7b872,0xbaa73872,0x323e3bd9,0xb23ebbd9
.long 0x361fb61f,0x361fb61f,0xbb643b64,0xbb643b64,0xbbd9b23e,0x3bd9323e,0x3aa73872,0xbaa7b872
.long 0x80008000,0x80008000,0x80008000,0x80008000,0xbb64b61f,0x3b64361f,0x3b64361f,0xbb64b61f
.long 0x39a8b9a8,0x39a8b9a8,0xb9a839a8,0xb9a839a8,0x361fbb64,0xb61f3b64,0xb61f3b64,0x361fbb64
.long 0xbc00bc00,0xbc00bc00,0x3c003c00,0x3c003c00,0x361fbb64,0xb61f3b64,0xb61f3b64,0x361fbb64
.long 0x39a8b9a8,0x39a8b9a8,0xb9a839a8,0xb9a839a8,0xbb64b61f,0x3b64361f,0x3b64361f,0xbb64b61f
.long 0x80008000,0x80008000,0x80008000,0x80008000,0x3b64361f,0xbb64b61f,0xbb64b61f,0x3b64361f
.long 0xb9a839a8,0xb9a839a8,0x39a8b9a8,0x39a8b9a8,0xb61f3b64,0x361fbb64,0x361fbb64,0xb61f3b64
.long 0x3c003c00,0x3c003c00,0xbc00bc00,0xbc00bc00,0xb61f3b64,0x361fbb64,0x361fbb64,0xb61f3b64
.long 0xb9a839a8,0xb9a839a8,0x39a8b9a8,0x39a8b9a8,0x3b64361f,0xbb64b61f,0xbb64b61f,0x3b64361f
.long 0x80008000,0x80008000,0x80008000,0x80008000,0xbaa7b872,0x3aa73872,0x3bd9323e,0xbbd9b23e
.long 0x3b64bb64,0x3b64bb64,0xb61f361f,0xb61f361f,0xb23ebbd9,0x323e3bd9,0xbaa73872,0x3aa7b872
.long 0xb9a8b9a8,0xb9a8b9a8,0x39a839a8,0x39a839a8,0x3bd9b23e,0xbbd9323e,0x38723aa7,0xb872baa7
.long 0xb61f361f,0xb61f361f,0xbb643b64,0xbb643b64,0xb8723aa7,0x3872baa7,0xb23e3bd9,0x323ebbd9
.long 0x3c003c00,0x3c003c00,0x3c003c00,0x3c003c00,0xb8723aa7,0x3872baa7,0xb23e3bd9,0x323ebbd9
.long 0xb61f361f,0xb61f361f,0xbb643b64,0xbb643b64,0x3bd9b23e,0xbbd9323e,0x38723aa7,0xb872baa7
.long 0xb9a8b9a8,0xb9a8b9a8,0x39a839a8,0x39a839a8,0xb23ebbd9,0x323e3bd9,0xbaa73872,0x3aa7b872
.long 0x3b64bb64,0x3b64bb64,0xb61f361f,0xb61f361f,0xbaa7b872,0x3aa73872,0x3bd9323e,0xbbd9b23e
.long 0x3c003c00,0x3c003c00,0x3c003c00,0x3c003c00,0x3c00,0x8000bc00,0xb9a839a8,0x39a8b9a8
.long 0xbc003c00,0xbc003c00,0x8000,0x8000,0x80003c00,0xbc00,0x39a8b9a8,0xb9a839a8
.long 0x3c003c00,0x3c003c00,0xbc00bc00,0xbc00bc00,0x3c00,0x8000bc00,0x39a8b9a8,0xb9a839a8
.long 0xbc003c00,0xbc003c00,0x80000000,0x80000000,0x80003c00,0xbc00,0xb9a839a8,0x39a8b9a8
.long 0x3c003c00,0x3c003c00,0x3c003c00,0x3c003c00,0x3c00,0x8000bc00,0xb9a839a8,0x39a8b9a8
.long 0xbc003c00,0xbc003c00,0x8000,0x8000,0x80003c00,0xbc00,0x39a8b9a8,0xb9a839a8
.long 0x3c003c00,0x3c003c00,0xbc00bc00,0xbc00bc00,0x3c00,0x8000bc00,0x39a8b9a8,0xb9a839a8
.long 0xbc003c00,0xbc003c00,0x80000000,0x80000000,0x80003c00,0xbc00,0xb9a839a8,0x39a8b9a8
.long 0xbc00bc00,0xbc00bc00,0xbc00bc00,0xbc00bc00,0x323ebbd9,0xb23e3bd9,0x3872baa7,0xb8723aa7
.long 0x3b64bb64,0x3b64bb64,0x361fb61f,0x361fb61f,0xb872baa7,0x38723aa7,0xbbd9323e,0x3bd9b23e
.long 0xb9a8b9a8,0xb9a8b9a8,0x39a839a8,0x39a839a8,0x3aa7b872,0xbaa73872,0x323e3bd9,0xb23ebbd9
.long 0x361fb61f,0x361fb61f,0xbb643b64,0xbb643b64,0xbbd9b23e,0x3bd9323e,0x3aa73872,0xbaa7b872
.long 0x80008000,0x80008000,0x80008000,0x80008000,0x3bd9323e,0xbbd9b23e,0xbaa7b872,0x3aa73872
.long 0xb61f361f,0xb61f361f,0x3b64bb64,0x3b64bb64,0xbaa73872,0x3aa7b872,0xb23ebbd9,0x323e3bd9
.long 0x39a839a8,0x39a839a8,0xb9a8b9a8,0xb9a8b9a8,0x38723aa7,0xb872baa7,0x3bd9b23e,0xbbd9323e
.long 0xbb643b64,0xbb643b64,0xb61f361f,0xb61f361f,0xb23e3bd9,0x323ebbd9,0xb8723aa7,0x3872baa7
.long 0x3c003c00,0x3c003c00,0x3c003c00,0x3c003c00,0xb61f3b64,0x361fbb64,0xb61f3b64,0x361fbb64
.long 0xb9a839a8,0xb9a839a8,0xb9a839a8,0xb9a839a8,0x3b64361f,0xbb64b61f,0x3b64361f,0xbb64b61f
.long 0x0,0x0,0x80008000,0x80008000,0xbb64b61f,0x3b64361f,0xbb64b61f,0x3b64361f
.long 0x39a8b9a8,0x39a8b9a8,0x39a8b9a8,0x39a8b9a8,0x361fbb64,0xb61f3b64,0x361fbb64,0xb61f3b64
.long 0xbc00bc00,0xbc00bc00,0xbc00bc00,0xbc00bc00,0x361fbb64,0xb61f3b64,0x361fbb64,0xb61f3b64
.long 0x39a8b9a8,0x39a8b9a8,0x39a8b9a8,0x39a8b9a8,0xbb64b61f,0x3b64361f,0xbb64b61f,0x3b64361f
.long 0x80008000,0x80008000,0x0,0x0,0x3b64361f,0xbb64b61f,0x3b64361f,0xbb64b61f
.long 0xb9a839a8,0xb9a839a8,0xb9a839a8,0xb9a839a8,0xb61f3b64,0x361fbb64,0xb61f3b64,0x361fbb64
.long 0xbc00bc00,0xbc00bc00,0xbc00bc00,0xbc00bc00,0x3872baa7,0xb8723aa7,0x323ebbd9,0xb23e3bd9
.long 0x361fb61f,0x361fb61f,0x3b64bb64,0x3b64bb64,0xbbd9323e,0x3bd9b23e,0xb872baa7,0x38723aa7
.long 0x39a839a8,0x39a839a8,0xb9a8b9a8,0xb9a8b9a8,0x323e3bd9,0xb23ebbd9,0x3aa7b872,0xbaa73872
.long 0xbb643b64,0xbb643b64,0x361fb61f,0x361fb61f,0x3aa73872,0xbaa7b872,0xbbd9b23e,0x3bd9323e
.long 0x0,0x0,0x0,0x0,0xbaa7b872,0x3aa73872,0x3bd9323e,0xbbd9b23e
.long 0x3b64bb64,0x3b64bb64,0xb61f361f,0xb61f361f,0xb23ebbd9,0x323e3bd9,0xbaa73872,0x3aa7b872
.long 0xb9a8b9a8,0xb9a8b9a8,0x39a839a8,0x39a839a8,0x3bd9b23e,0xbbd9323e,0x38723aa7,0xb872baa7
.long 0xb61f361f,0xb61f361f,0xbb643b64,0xbb643b64,0xb8723aa7,0x3872baa7,0xb23e3bd9,0x323ebbd9
.long 0x80008000,0x80008000,0x80008000,0x80008000,0xbc008000,0x3c008000,0x39a839a8,0xb9a8b9a8
.long 0x80008000,0x80008000,0xbc003c00,0xbc003c00,0x3c008000,0xbc008000,0x39a839a8,0xb9a8b9a8
.long 0x80008000,0x80008000,0x80008000,0x80008000,0xbc008000,0x3c008000,0xb9a8b9a8,0x39a839a8
.long 0x80008000,0x80008000,0x3c00bc00,0x3c00bc00,0x3c008000,0xbc008000,0xb9a8b9a8,0x39a839a8
.long 0x80008000,0x80008000,0x80008000,0x80008000,0xbc008000,0x3c008000,0x39a839a8,0xb9a8b9a8
.long 0x80008000,0x80008000,0xbc003c00,0xbc003c00,0x3c008000,0xbc008000,0x39a839a8,0xb9a8b9a8
.long 0x80008000,0x80008000,0x80008000,0x80008000,0xbc008000,0x3c008000,0xb9a8b9a8,0x39a839a8
.long 0x80008000,0x80008000,0x3c00bc00,0x3c00bc00,0x3c008000,0xbc008000,0xb9a8b9a8,0x39a839a8
.long 0x80008000,0x80008000,0x80008000,0x80008000,0x3bd9323e,0xbbd9b23e,0xbaa7b872,0x3aa73872
.long 0xb61f361f,0xb61f361f,0x3b64bb64,0x3b64bb64,0xbaa73872,0x3aa7b872,0xb23ebbd9,0x323e3bd9
.long 0x39a839a8,0x39a839a8,0xb9a8b9a8,0xb9a8b9a8,0x38723aa7,0xb872baa7,0x3bd9b23e,0xbbd9323e
.long 0xbb643b64,0xbb643b64,0xb61f361f,0xb61f361f,0xb23e3bd9,0x323ebbd9,0xb8723aa7,0x3872baa7
.long 0x3c003c00,0x3c003c00,0x3c003c00,0x3c003c00,0xb23e3bd9,0x323ebbd9,0xb8723aa7,0x3872baa7
.long 0xbb643b64,0xbb643b64,0xb61f361f,0xb61f361f,0x38723aa7,0xb872baa7,0x3bd9b23e,0xbbd9323e
.long 0x39a839a8,0x39a839a8,0xb9a8b9a8,0xb9a8b9a8,0xbaa73872,0x3aa7b872,0xb23ebbd9,0x323e3bd9
.long 0xb61f361f,0xb61f361f,0x3b64bb64,0x3b64bb64,0x3bd9323e,0xbbd9b23e,0xbaa7b872,0x3aa73872
.long 0x80008000,0x80008000,0x80008000,0x80008000,0xbb64b61f,0x3b64361f,0x3b64361f,0xbb64b61f
.long 0x39a8b9a8,0x39a8b9a8,0xb9a839a8,0xb9a839a8,0x361fbb64,0xb61f3b64,0xb61f3b64,0x361fbb64
.long 0xbc00bc00,0xbc00bc00,0x3c003c00,0x3c003c00,0x361fbb64,0xb61f3b64,0xb61f3b64,0x361fbb64
.long 0x39a8b9a8,0x39a8b9a8,0xb9a839a8,0xb9a839a8,0xbb64b61f,0x3b64361f,0x3b64361f,0xbb64b61f
.long 0x80008000,0x80008000,0x80008000,0x80008000,0x3b64361f,0xbb64b61f,0xbb64b61f,0x3b64361f
.long 0xb9a839a8,0xb9a839a8,0x39a8b9a8,0x39a8b9a8,0xb61f3b64,0x361fbb64,0x361fbb64,0xb61f3b64
.long 0x3c003c00,0x3c003c00,0xbc00bc00,0xbc00bc00,0xb61f3b64,0x361fbb64,0x361fbb64,0xb61f3b64
.long 0xb9a839a8,0xb9a839a8,0x39a8b9a8,0x39a8b9a8,0x3b64361f,0xbb64b61f,0xbb64b61f,0x3b64361f
.long 0x80008000,0x80008000,0x80008000,0x80008000,0x3aa73872,0xbaa7b872,0xbbd9b23e,0x3bd9323e
.long 0xbb643b64,0xbb643b64,0x361fb61f,0x361fb61f,0x323e3bd9,0xb23ebbd9,0x3aa7b872,0xbaa73872
.long 0x39a839a8,0x39a839a8,0xb9a8b9a8,0xb9a8b9a8,0xbbd9323e,0x3bd9b23e,0xb872baa7,0x38723aa7
.long 0x361fb61f,0x361fb61f,0x3b64bb64,0x3b64bb64,0x3872baa7,0xb8723aa7,0x323ebbd9,0xb23e3bd9
.long 0xbc00bc00,0xbc00bc00,0xbc00bc00,0xbc00bc00,0x3872baa7,0xb8723aa7,0x323ebbd9,0xb23e3bd9
.long 0x361fb61f,0x361fb61f,0x3b64bb64,0x3b64bb64,0xbbd9323e,0x3bd9b23e,0xb872baa7,0x38723aa7
.long 0x39a839a8,0x39a839a8,0xb9a8b9a8,0xb9a8b9a8,0x323e3bd9,0xb23ebbd9,0x3aa7b872,0xbaa73872
.long 0xbb643b64,0xbb643b64,0x361fb61f,0x361fb61f,0x3aa73872,0xbaa7b872,0xbbd9b23e,0x3bd9323e
.long 0x3c003c00,0x3c003c00,0x3c003c00,0x3c003c00,0x3c003c00,0xbc00bc00,0x3c003c00,0xbc00bc00
.long 0xbc003c00,0xbc003c00,0xbc003c00,0xbc003c00,0xbc003c00,0x3c00bc00,0xbc003c00,0x3c00bc00
.long 0x3c5f3c00,0x3cfd3cb4,0x3d6a3d3a,0x3da13d8c,0x3b2d3c00,0xb955bcb4,0x36923d3a,0xb070bd8c
.long 0xbc5f3c00,0xbcfd3cb4,0xbd6a3d3a,0xbda13d8c,0xbb2d3c00,0x3955bcb4,0xb6923d3a,0x3070bd8c
.long 0x3cb43c00,0x3d8c3d3a,0x3d8c3da8,0x3cb43d3a,0x3a493c00,0xb46abd3a,0xb46a3da8,0x3a49bd3a
.long 0xbcb43c00,0xbd8c3d3a,0xbd8c3da8,0xbcb43d3a,0xba493c00,0x346abd3a,0x346a3da8,0xba49bd3a
.long 0x3cfd3c00,0x3da13d8c,0x3c5f3d3a,0x36923a49,0x39553c00,0x3070bd8c,0xbb2d3d3a,0x3d6aba49
.long 0xbcfd3c00,0xbda13d8c,0xbc5f3d3a,0xb6923a49,0xb9553c00,0xb070bd8c,0x3b2d3d3a,0xbd6aba49
.long 0x3c003c00,0x3c003c00,0x3c003c00,0x3c003c00,0x3c003c00,0xbc00bc00,0x3c003c00,0xbc00bc00
.long 0xbc003c00,0xbc003c00,0xbc003c00,0xbc003c00,0xbc003c00,0x3c00bc00,0xbc003c00,0x3c00bc00
.long 0x3da13da8,0x3d6a3d8c,0x3cfd3d3a,0x3c5f3cb4,0xb0703da8,0x3692bd8c,0xb9553d3a,0x3b2dbcb4
.long 0xbda13da8,0xbd6a3d8c,0xbcfd3d3a,0xbc5f3cb4,0x30703da8,0xb692bd8c,0x39553d3a,0xbb2dbcb4
.long 0x3a493c00,0x346a3854,0xb46a0000,0xba49b854,0xbcb43c00,0x3d8cb854,0xbd8c0000,0x3cb43854
.long 0xba493c00,0xb46a3854,0x346a0000,0x3a49b854,0x3cb43c00,0xbd8cb854,0x3d8c0000,0xbcb43854
.long 0xb6920000,0xbc5fba49,0xbda1bd3a,0xbcfdbd8c,0xbd6a0000,0x3b2d3a49,0xb070bd3a,0xb9553d8c
.long 0x36920000,0x3c5fba49,0x3da1bd3a,0x3cfdbd8c,0x3d6a0000,0xbb2d3a49,0x3070bd3a,0x39553d8c
.long 0x3c003c00,0x3c003c00,0x3c003c00,0x3c003c00,0x3c003c00,0xbc00bc00,0x3c003c00,0xbc00bc00
.long 0xbc003c00,0xbc003c00,0xbc003c00,0xbc003c00,0xbc003c00,0x3c00bc00,0xbc003c00,0x3c00bc00
.long 0x3b2d3c00,0x39553a49,0x36923854,0x3070346a,0xbc5f3c00,0x3cfdba49,0xbd6a3854,0x3da1b46a
.long 0xbb2d3c00,0xb9553a49,0xb6923854,0xb070346a,0x3c5f3c00,0xbcfdba49,0x3d6a3854,0xbda1b46a
.long 0xbcb4bc00,0xbd8cbd3a,0xbd8cbda8,0xbcb4bd3a,0xba49bc00,0x346a3d3a,0x346abda8,0xba493d3a
.long 0x3cb4bc00,0x3d8cbd3a,0x3d8cbda8,0x3cb4bd3a,0x3a49bc00,0xb46a3d3a,0xb46abda8,0x3a493d3a
.long 0xb955bc00,0x3070b46a,0x3b2d3854,0x3d6a3cb4,0x3cfdbc00,0xbda1346a,0x3c5f3854,0xb692bcb4
.long 0x3955bc00,0xb070b46a,0xbb2d3854,0xbd6a3cb4,0xbcfdbc00,0x3da1346a,0xbc5f3854,0x3692bcb4
.long 0x3c003c00,0x3c003c00,0x3c003c00,0x3c003c00,0x3c003c00,0xbc00bc00,0x3c003c00,0xbc00bc00
.long 0xbc003c00,0xbc003c00,0xbc003c00,0xbc003c00,0xbc003c00,0x3c00bc00,0xbc003c00,0x3c00bc00
.long 0xb0700000,0xb692b46a,0xb955b854,0xbb2dba49,0xbda10000,0x3d6a346a,0xbcfdb854,0x3c5f3a49
.long 0x30700000,0x3692b46a,0x3955b854,0x3b2dba49,0x3da10000,0xbd6a346a,0x3cfdb854,0xbc5f3a49
.long 0xba49bc00,0xb46ab854,0x346a8000,0x3a493854,0x3cb4bc00,0xbd8c3854,0x3d8c8000,0xbcb4b854
.long 0x3a49bc00,0x346ab854,0xb46a8000,0xba493854,0xbcb4bc00,0x3d8c3854,0xbd8c8000,0x3cb4b854
.long 0x3d6a3da8,0x3b2d3cb4,0x30703854,0xb955b46a,0xb6923da8,0x3c5fbcb4,0xbda13854,0x3cfd346a
.long 0xbd6a3da8,0xbb2d3cb4,0xb0703854,0x3955b46a,0x36923da8,0xbc5fbcb4,0x3da13854,0xbcfd346a
.long 0x3c003c00,0x3c003c00,0x3c003c00,0x3c003c00,0x3c003c00,0xbc00bc00,0x3c003c00,0xbc00bc00
.long 0xbc003c00,0xbc003c00,0xbc003c00,0xbc003c00,0xbc003c00,0x3c00bc00,0xbc003c00,0x3c00bc00
.long 0xbc5fbc00,0xbcfdbcb4,0xbd6abd3a,0xbda1bd8c,0xbb2dbc00,0x39553cb4,0xb692bd3a,0x30703d8c
.long 0x3c5fbc00,0x3cfdbcb4,0x3d6abd3a,0x3da1bd8c,0x3b2dbc00,0xb9553cb4,0x3692bd3a,0xb0703d8c
.long 0x3cb43c00,0x3d8c3d3a,0x3d8c3da8,0x3cb43d3a,0x3a493c00,0xb46abd3a,0xb46a3da8,0x3a49bd3a
.long 0xbcb43c00,0xbd8c3d3a,0xbd8c3da8,0xbcb43d3a,0xba493c00,0x346abd3a,0x346a3da8,0xba49bd3a
.long 0xbcfdbc00,0xbda1bd8c,0xbc5fbd3a,0xb692ba49,0xb955bc00,0xb0703d8c,0x3b2dbd3a,0xbd6a3a49
.long 0x3cfdbc00,0x3da1bd8c,0x3c5fbd3a,0x3692ba49,0x3955bc00,0x30703d8c,0xbb2dbd3a,0x3d6a3a49
.long 0x3c003c00,0x3c003c00,0x3c003c00,0x3c003c00,0x3c003c00,0xbc00bc00,0x3c003c00,0xbc00bc00
.long 0xbc003c00,0xbc003c00,0xbc003c00,0xbc003c00,0xbc003c00,0x3c00bc00,0xbc003c00,0x3c00bc00
.long 0xbda1bda8,0xbd6abd8c,0xbcfdbd3a,0xbc5fbcb4,0x3070bda8,0xb6923d8c,0x3955bd3a,0xbb2d3cb4
.long 0x3da1bda8,0x3d6abd8c,0x3cfdbd3a,0x3c5fbcb4,0xb070bda8,0x36923d8c,0xb955bd3a,0x3b2d3cb4
.long 0x3a493c00,0x346a3854,0xb46a0000,0xba49b854,0xbcb43c00,0x3d8cb854,0xbd8c0000,0x3cb43854
.long 0xba493c00,0xb46a3854,0x346a0000,0x3a49b854,0x3cb43c00,0xbd8cb854,0x3d8c0000,0xbcb43854
.long 0x36928000,0x3c5f3a49,0x3da13d3a,0x3cfd3d8c,0x3d6a8000,0xbb2dba49,0x30703d3a,0x3955bd8c
.long 0xb6928000,0xbc5f3a49,0xbda13d3a,0xbcfd3d8c,0xbd6a8000,0x3b2dba49,0xb0703d3a,0xb955bd8c
.long 0x3c003c00,0x3c003c00,0x3c003c00,0x3c003c00,0x3c003c00,0xbc00bc00,0x3c003c00,0xbc00bc00
.long 0xbc003c00,0xbc003c00,0xbc003c00,0xbc003c00,0xbc003c00,0x3c00bc00,0xbc003c00,0x3c00bc00
.long 0xbb2dbc00,0xb955ba49,0xb692b854,0xb070b46a,0x3c5fbc00,0xbcfd3a49,0x3d6ab854,0xbda1346a
.long 0x3b2dbc00,0x3955ba49,0x3692b854,0x3070b46a,0xbc5fbc00,0x3cfd3a49,0xbd6ab854,0x3da1346a
.long 0xbcb4bc00,0xbd8cbd3a,0xbd8cbda8,0xbcb4bd3a,0xba49bc00,0x346a3d3a,0x346abda8,0xba493d3a
.long 0x3cb4bc00,0x3d8cbd3a,0x3d8cbda8,0x3cb4bd3a,0x3a49bc00,0xb46a3d3a,0xb46abda8,0x3a493d3a
.long 0x39553c00,0xb070346a,0xbb2db854,0xbd6abcb4,0xbcfd3c00,0x3da1b46a,0xbc5fb854,0x36923cb4
.long 0xb9553c00,0x3070346a,0x3b2db854,0x3d6abcb4,0x3cfd3c00,0xbda1b46a,0x3c5fb854,0xb6923cb4
.long 0x3c003c00,0x3c003c00,0x3c003c00,0x3c003c00,0x3c003c00,0xbc00bc00,0x3c003c00,0xbc00bc00
.long 0xbc003c00,0xbc003c00,0xbc003c00,0xbc003c00,0xbc003c00,0x3c00bc00,0xbc003c00,0x3c00bc00
.long 0x30708000,0x3692346a,0x39553854,0x3b2d3a49,0x3da18000,0xbd6ab46a,0x3cfd3854,0xbc5fba49
.long 0xb0708000,0xb692346a,0xb9553854,0xbb2d3a49,0xbda18000,0x3d6ab46a,0xbcfd3854,0x3c5fba49
.long 0xba49bc00,0xb46ab854,0x346a8000,0x3a493854,0x3cb4bc00,0xbd8c3854,0x3d8c8000,0xbcb4b854
.long 0x3a49bc00,0x346ab854,0xb46a8000,0xba493854,0xbcb4bc00,0x3d8c3854,0xbd8c8000,0x3cb4b854
.long 0xbd6abda8,0xbb2dbcb4,0xb070b854,0x3955346a,0x3692bda8,0xbc5f3cb4,0x3da1b854,0xbcfdb46a
.long 0x3d6abda8,0x3b2dbcb4,0x3070b854,0xb955346a,0xb692bda8,0x3c5f3cb4,0xbda1b854,0x3cfdb46a
.long 0xbc00bc00,0xbc00bc00,0xbc00bc00,0xbc00bc00,0x3c00bc00,0xbc003c00,0x3c00bc00,0xbc003c00
.long 0x3c00bc00,0x3c00bc00,0x3c00bc00,0x3c00bc00,0xbc00bc00,0x3c003c00,0xbc00bc00,0x3c003c00
.long 0xbb2dbc00,0xb955ba49,0xb692b854,0xb070b46a,0x3c5fbc00,0xbcfd3a49,0x3d6ab854,0xbda1346a
.long 0x3b2dbc00,0x3955ba49,0x3692b854,0x3070b46a,0xbc5fbc00,0x3cfd3a49,0xbd6ab854,0x3da1346a
.long 0xba49bc00,0xb46ab854,0x346a8000,0x3a493854,0x3cb4bc00,0xbd8c3854,0x3d8c8000,0xbcb4b854
.long 0x3a49bc00,0x346ab854,0xb46a8000,0xba493854,0xbcb4bc00,0x3d8c3854,0xbd8c8000,0x3cb4b854
.long 0xb955bc00,0x3070b46a,0x3b2d3854,0x3d6a3cb4,0x3cfdbc00,0xbda1346a,0x3c5f3854,0xb692bcb4
.long 0x3955bc00,0xb070b46a,0xbb2d3854,0xbd6a3cb4,0xbcfdbc00,0x3da1346a,0xbc5f3854,0x3692bcb4
.long 0xbc00bc00,0xbc00bc00,0xbc00bc00,0xbc00bc00,0x3c00bc00,0xbc003c00,0x3c00bc00,0xbc003c00
.long 0x3c00bc00,0x3c00bc00,0x3c00bc00,0x3c00bc00,0xbc00bc00,0x3c003c00,0xbc00bc00,0x3c003c00
.long 0x30708000,0x3692346a,0x39553854,0x3b2d3a49,0x3da18000,0xbd6ab46a,0x3cfd3854,0xbc5fba49
.long 0xb0708000,0xb692346a,0xb9553854,0xbb2d3a49,0xbda18000,0x3d6ab46a,0xbcfd3854,0x3c5fba49
.long 0x3cb43c00,0x3d8c3d3a,0x3d8c3da8,0x3cb43d3a,0x3a493c00,0xb46abd3a,0xb46a3da8,0x3a49bd3a
.long 0xbcb43c00,0xbd8c3d3a,0xbd8c3da8,0xbcb43d3a,0xba493c00,0x346abd3a,0x346a3da8,0xba49bd3a
.long 0x3d6a3da8,0x3b2d3cb4,0x30703854,0xb955b46a,0xb6923da8,0x3c5fbcb4,0xbda13854,0x3cfd346a
.long 0xbd6a3da8,0xbb2d3cb4,0xb0703854,0x3955b46a,0x36923da8,0xbc5fbcb4,0x3da13854,0xbcfd346a
.long 0xbc00bc00,0xbc00bc00,0xbc00bc00,0xbc00bc00,0x3c00bc00,0xbc003c00,0x3c00bc00,0xbc003c00
.long 0x3c00bc00,0x3c00bc00,0x3c00bc00,0x3c00bc00,0xbc00bc00,0x3c003c00,0xbc00bc00,0x3c003c00
.long 0x3c5f3c00,0x3cfd3cb4,0x3d6a3d3a,0x3da13d8c,0x3b2d3c00,0xb955bcb4,0x36923d3a,0xb070bd8c
.long 0xbc5f3c00,0xbcfd3cb4,0xbd6a3d3a,0xbda13d8c,0xbb2d3c00,0x3955bcb4,0xb6923d3a,0x3070bd8c
.long 0x3a493c00,0x346a3854,0xb46a0000,0xba49b854,0xbcb43c00,0x3d8cb854,0xbd8c0000,0x3cb43854
.long 0xba493c00,0xb46a3854,0x346a0000,0x3a49b854,0x3cb43c00,0xbd8cb854,0x3d8c0000,0xbcb43854
.long 0xbcfdbc00,0xbda1bd8c,0xbc5fbd3a,0xb692ba49,0xb955bc00,0xb0703d8c,0x3b2dbd3a,0xbd6a3a49
.long 0x3cfdbc00,0x3da1bd8c,0x3c5fbd3a,0x3692ba49,0x3955bc00,0x30703d8c,0xbb2dbd3a,0x3d6a3a49
.long 0xbc00bc00,0xbc00bc00,0xbc00bc00,0xbc00bc00,0x3c00bc00,0xbc003c00,0x3c00bc00,0xbc003c00
.long 0x3c00bc00,0x3c00bc00,0x3c00bc00,0x3c00bc00,0xbc00bc00,0x3c003c00,0xbc00bc00,0x3c003c00
.long 0x3da13da8,0x3d6a3d8c,0x3cfd3d3a,0x3c5f3cb4,0xb0703da8,0x3692bd8c,0xb9553d3a,0x3b2dbcb4
.long 0xbda13da8,0xbd6a3d8c,0xbcfd3d3a,0xbc5f3cb4,0x30703da8,0xb692bd8c,0x39553d3a,0xbb2dbcb4
.long 0xbcb4bc00,0xbd8cbd3a,0xbd8cbda8,0xbcb4bd3a,0xba49bc00,0x346a3d3a,0x346abda8,0xba493d3a
.long 0x3cb4bc00,0x3d8cbd3a,0x3d8cbda8,0x3cb4bd3a,0x3a49bc00,0xb46a3d3a,0xb46abda8,0x3a493d3a
.long 0x36928000,0x3c5f3a49,0x3da13d3a,0x3cfd3d8c,0x3d6a8000,0xbb2dba49,0x30703d3a,0x3955bd8c
.long 0xb6928000,0xbc5f3a49,0xbda13d3a,0xbcfd3d8c,0xbd6a8000,0x3b2dba49,0xb0703d3a,0xb955bd8c
.long 0xbc00bc00,0xbc00bc00,0xbc00bc00,0xbc00bc00,0x3c00bc00,0xbc003c00,0x3c00bc00,0xbc003c00
.long 0x3c00bc00,0x3c00bc00,0x3c00bc00,0x3c00bc00,0xbc00bc00,0x3c003c00,0xbc00bc00,0x3c003c00
.long 0x3b2d3c00,0x39553a49,0x36923854,0x3070346a,0xbc5f3c00,0x3cfdba49,0xbd6a3854,0x3da1b46a
.long 0xbb2d3c00,0xb9553a49,0xb6923854,0xb070346a,0x3c5f3c00,0xbcfdba49,0x3d6a3854,0xbda1b46a
.long 0xba49bc00,0xb46ab854,0x346a8000,0x3a493854,0x3cb4bc00,0xbd8c3854,0x3d8c8000,0xbcb4b854
.long 0x3a49bc00,0x346ab854,0xb46a8000,0xba493854,0xbcb4bc00,0x3d8c3854,0xbd8c8000,0x3cb4b854
.long 0x39553c00,0xb070346a,0xbb2db854,0xbd6abcb4,0xbcfd3c00,0x3da1b46a,0xbc5fb854,0x36923cb4
.long 0xb9553c00,0x3070346a,0x3b2db854,0x3d6abcb4,0x3cfd3c00,0xbda1b46a,0x3c5fb854,0xb6923cb4
.long 0xbc00bc00,0xbc00bc00,0xbc00bc00,0xbc00bc00,0x3c00bc00,0xbc003c00,0x3c00bc00,0xbc003c00
.long 0x3c00bc00,0x3c00bc00,0x3c00bc00,0x3c00bc00,0xbc00bc00,0x3c003c00,0xbc00bc00,0x3c003c00
.long 0xb0700000,0xb692b46a,0xb955b854,0xbb2dba49,0xbda10000,0x3d6a346a,0xbcfdb854,0x3c5f3a49
.long 0x30700000,0x3692b46a,0x3955b854,0x3b2dba49,0x3da10000,0xbd6a346a,0x3cfdb854,0xbc5f3a49
.long 0x3cb43c00,0x3d8c3d3a,0x3d8c3da8,0x3cb43d3a,0x3a493c00,0xb46abd3a,0xb46a3da8,0x3a49bd3a
.long 0xbcb43c00,0xbd8c3d3a,0xbd8c3da8,0xbcb43d3a,0xba493c00,0x346abd3a,0x346a3da8,0xba49bd3a
.long 0xbd6abda8,0xbb2dbcb4,0xb070b854,0x3955346a,0x3692bda8,0xbc5f3cb4,0x3da1b854,0xbcfdb46a
.long 0x3d6abda8,0x3b2dbcb4,0x3070b854,0xb955346a,0xb692bda8,0x3c5f3cb4,0xbda1b854,0x3cfdb46a
.long 0xbc00bc00,0xbc00bc00,0xbc00bc00,0xbc00bc00,0x3c00bc00,0xbc003c00,0x3c00bc00,0xbc003c00
.long 0x3c00bc00,0x3c00bc00,0x3c00bc00,0x3c00bc00,0xbc00bc00,0x3c003c00,0xbc00bc00,0x3c003c00
.long 0xbc5fbc00,0xbcfdbcb4,0xbd6abd3a,0xbda1bd8c,0xbb2dbc00,0x39553cb4,0xb692bd3a,0x30703d8c
.long 0x3c5fbc00,0x3cfdbcb4,0x3d6abd3a,0x3da1bd8c,0x3b2dbc00,0xb9553cb4,0x3692bd3a,0xb0703d8c
.long 0x3a493c00,0x346a3854,0xb46a0000,0xba49b854,0xbcb43c00,0x3d8cb854,0xbd8c0000,0x3cb43854
.long 0xba493c00,0xb46a3854,0x346a0000,0x3a49b854,0x3cb43c00,0xbd8cb854,0x3d8c0000,0xbcb43854
.long 0x3cfd3c00,0x3da13d8c,0x3c5f3d3a,0x36923a49,0x39553c00,0x3070bd8c,0xbb2d3d3a,0x3d6aba49
.long 0xbcfd3c00,0xbda13d8c,0xbc5f3d3a,0xb6923a49,0xb9553c00,0xb070bd8c,0x3b2d3d3a,0xbd6aba49
.long 0xbc00bc00,0xbc00bc00,0xbc00bc00,0xbc00bc00,0x3c00bc00,0xbc003c00,0x3c00bc00,0xbc003c00
.long 0x3c00bc00,0x3c00bc00,0x3c00bc00,0x3c00bc00,0xbc00bc00,0x3c003c00,0xbc00bc00,0x3c003c00
.long 0xbda1bda8,0xbd6abd8c,0xbcfdbd3a,0xbc5fbcb4,0x3070bda8,0xb6923d8c,0x3955bd3a,0xbb2d3cb4
.long 0x3da1bda8,0x3d6abd8c,0x3cfdbd3a,0x3c5fbcb4,0xb070bda8,0x36923d8c,0xb955bd3a,0x3b2d3cb4
.long 0xbcb4bc00,0xbd8cbd3a,0xbd8cbda8,0xbcb4bd3a,0xba49bc00,0x346a3d3a,0x346abda8,0xba493d3a
.long 0x3cb4bc00,0x3d8cbd3a,0x3d8cbda8,0x3cb4bd3a,0x3a49bc00,0xb46a3d3a,0xb46abda8,0x3a493d3a
.long 0xb6920000,0xbc5fba49,0xbda1bd3a,0xbcfdbd8c,0xbd6a0000,0x3b2d3a49,0xb070bd3a,0xb9553d8c
.long 0x36920000,0x3c5fba49,0x3da1bd3a,0x3cfdbd8c,0x3d6a0000,0xbb2d3a49,0x3070bd3a,0x39553d8c
.long 0x3d3a3c00,0x3d3a3da8,0x38543c00,0xb8540000,0x38543c00,0x3854bda8,0xbd3a3c00,0x3d3a8000
.long 0xbd3a3c00,0xbd3a3da8,0xb8543c00,0x38540000,0xb8543c00,0xb854bda8,0x3d3a3c00,0xbd3a8000
.long 0x3d6a3c00,0x3c5f3d8c,0xb0703854,0xbcfdba49,0x36923c00,0x3b2dbd8c,0xbda13854,0x39553a49
.long 0xbd6a3c00,0xbc5f3d8c,0x30703854,0x3cfdba49,0xb6923c00,0xbb2dbd8c,0x3da13854,0xb9553a49
.long 0x3d8c3c00,0x3a493d3a,0xba490000,0xbd8cbd3a,0x346a3c00,0x3cb4bd3a,0xbcb40000,0xb46a3d3a
.long 0xbd8c3c00,0xba493d3a,0x3a490000,0x3d8cbd3a,0xb46a3c00,0xbcb4bd3a,0x3cb40000,0x346a3d3a
.long 0x3da13c00,0x36923cb4,0xbcfdb854,0xbb2dbd8c,0x30703c00,0x3d6abcb4,0xb955b854,0xbc5f3d8c
.long 0xbda13c00,0xb6923cb4,0x3cfdb854,0x3b2dbd8c,0xb0703c00,0xbd6abcb4,0x3955b854,0x3c5f3d8c
.long 0xbd3abc00,0xbd3abda8,0xb854bc00,0x38548000,0xb854bc00,0xb8543da8,0x3d3abc00,0xbd3a0000
.long 0x3d3abc00,0x3d3abda8,0x3854bc00,0xb8548000,0x3854bc00,0x38543da8,0xbd3abc00,0x3d3a0000
.long 0xbcfdbda8,0xb070ba49,0x3c5f3854,0x3d6a3d8c,0x3955bda8,0xbda13a49,0x3b2d3854,0x3692bd8c
.long 0x3cfdbda8,0x3070ba49,0xbc5f3854,0xbd6a3d8c,0xb955bda8,0x3da13a49,0xbb2d3854,0xb692bd8c
.long 0xb46abc00,0x3cb43854,0x3cb43da8,0xb46a3854,0x3d8cbc00,0xba49b854,0xba493da8,0x3d8cb854
.long 0x346abc00,0xbcb43854,0xbcb43da8,0x346a3854,0xbd8cbc00,0x3a49b854,0x3a493da8,0xbd8cb854
.long 0x3b2d8000,0x3cfd3d8c,0xb6923854,0xbda1bcb4,0x3c5f8000,0x3955bd8c,0xbd6a3854,0xb0703cb4
.long 0xbb2d8000,0xbcfd3d8c,0x36923854,0x3da1bcb4,0xbc5f8000,0xb955bd8c,0x3d6a3854,0x30703cb4
.long 0x3d3a3c00,0x3d3a3da8,0x38543c00,0xb8540000,0x38543c00,0x3854bda8,0xbd3a3c00,0x3d3a8000
.long 0xbd3a3c00,0xbd3a3da8,0xb8543c00,0x38540000,0xb8543c00,0xb854bda8,0x3d3a3c00,0xbd3a8000
.long 0x36923c00,0xbb2db46a,0xbda1bd3a,0xb955bcb4,0xbd6a3c00,0x3c5f346a,0x3070bd3a,0xbcfd3cb4
.long 0xb6923c00,0x3b2db46a,0x3da1bd3a,0x3955bcb4,0x3d6a3c00,0xbc5f346a,0xb070bd3a,0x3cfd3cb4
.long 0xbd8cbc00,0xba49bd3a,0x3a498000,0x3d8c3d3a,0xb46abc00,0xbcb43d3a,0x3cb48000,0x346abd3a
.long 0x3d8cbc00,0x3a49bd3a,0xba498000,0xbd8c3d3a,0x346abc00,0x3cb43d3a,0xbcb48000,0xb46abd3a
.long 0xb070bc00,0x3d6a3a49,0x39553d3a,0xbc5fb46a,0x3da1bc00,0xb692ba49,0xbcfd3d3a,0x3b2d346a
.long 0x3070bc00,0xbd6a3a49,0xb9553d3a,0x3c5fb46a,0xbda1bc00,0x3692ba49,0x3cfd3d3a,0xbb2d346a
.long 0xbd3abc00,0xbd3abda8,0xb854bc00,0x38548000,0xb854bc00,0xb8543da8,0x3d3abc00,0xbd3a0000
.long 0x3d3abc00,0x3d3abda8,0x3854bc00,0xb8548000,0x3854bc00,0x38543da8,0xbd3abc00,0x3d3a0000
.long 0x39558000,0x3da13cb4,0x3b2d3d3a,0xb692346a,0x3cfd8000,0xb070bcb4,0xbc5f3d3a,0x3d6ab46a
.long 0xb9558000,0xbda13cb4,0xbb2d3d3a,0x3692346a,0xbcfd8000,0x3070bcb4,0x3c5f3d3a,0xbd6ab46a
.long 0x346a3c00,0xbcb4b854,0xbcb4bda8,0x346ab854,0xbd8c3c00,0x3a493854,0x3a49bda8,0xbd8c3854
.long 0xb46a3c00,0x3cb4b854,0x3cb4bda8,0xb46ab854,0x3d8c3c00,0xba493854,0xba49bda8,0x3d8c3854
.long 0xbc5fbda8,0x3955b46a,0x3d6a3d3a,0xb0703a49,0x3b2dbda8,0xbcfd346a,0xb6923d3a,0x3da1ba49
.long 0x3c5fbda8,0xb955b46a,0xbd6a3d3a,0x30703a49,0xbb2dbda8,0x3cfd346a,0x36923d3a,0xbda1ba49
.long 0x3d3a3c00,0x3d3a3da8,0x38543c00,0xb8540000,0x38543c00,0x3854bda8,0xbd3a3c00,0x3d3a8000
.long 0xbd3a3c00,0xbd3a3da8,0xb8543c00,0x38540000,0xb8543c00,0xb854bda8,0x3d3a3c00,0xbd3a8000
.long 0xbd6abc00,0xbc5fbd8c,0x3070b854,0x3cfd3a49,0xb692bc00,0xbb2d3d8c,0x3da1b854,0xb955ba49
.long 0x3d6abc00,0x3c5fbd8c,0xb070b854,0xbcfd3a49,0x3692bc00,0x3b2d3d8c,0xbda1b854,0x3955ba49
.long 0x3d8c3c00,0x3a493d3a,0xba490000,0xbd8cbd3a,0x346a3c00,0x3cb4bd3a,0xbcb40000,0xb46a3d3a
.long 0xbd8c3c00,0xba493d3a,0x3a490000,0x3d8cbd3a,0xb46a3c00,0xbcb4bd3a,0x3cb40000,0x346a3d3a
.long 0xbda1bc00,0xb692bcb4,0x3cfd3854,0x3b2d3d8c,0xb070bc00,0xbd6a3cb4,0x39553854,0x3c5fbd8c
.long 0x3da1bc00,0x3692bcb4,0xbcfd3854,0xbb2d3d8c,0x3070bc00,0x3d6a3cb4,0xb9553854,0xbc5fbd8c
.long 0xbd3abc00,0xbd3abda8,0xb854bc00,0x38548000,0xb854bc00,0xb8543da8,0x3d3abc00,0xbd3a0000
.long 0x3d3abc00,0x3d3abda8,0x3854bc00,0xb8548000,0x3854bc00,0x38543da8,0xbd3abc00,0x3d3a0000
.long 0x3cfd3da8,0x30703a49,0xbc5fb854,0xbd6abd8c,0xb9553da8,0x3da1ba49,0xbb2db854,0xb6923d8c
.long 0xbcfd3da8,0xb0703a49,0x3c5fb854,0x3d6abd8c,0x39553da8,0xbda1ba49,0x3b2db854,0x36923d8c
.long 0xb46abc00,0x3cb43854,0x3cb43da8,0xb46a3854,0x3d8cbc00,0xba49b854,0xba493da8,0x3d8cb854
.long 0x346abc00,0xbcb43854,0xbcb43da8,0x346a3854,0xbd8cbc00,0x3a49b854,0x3a493da8,0xbd8cb854
.long 0xbb2d0000,0xbcfdbd8c,0x3692b854,0x3da13cb4,0xbc5f0000,0xb9553d8c,0x3d6ab854,0x3070bcb4
.long 0x3b2d0000,0x3cfdbd8c,0xb692b854,0xbda13cb4,0x3c5f0000,0x39553d8c,0xbd6ab854,0xb070bcb4
.long 0x3d3a3c00,0x3d3a3da8,0x38543c00,0xb8540000,0x38543c00,0x3854bda8,0xbd3a3c00,0x3d3a8000
.long 0xbd3a3c00,0xbd3a3da8,0xb8543c00,0x38540000,0xb8543c00,0xb854bda8,0x3d3a3c00,0xbd3a8000
.long 0xb692bc00,0x3b2d346a,0x3da13d3a,0x39553cb4,0x3d6abc00,0xbc5fb46a,0xb0703d3a,0x3cfdbcb4
.long 0x3692bc00,0xbb2d346a,0xbda13d3a,0xb9553cb4,0xbd6abc00,0x3c5fb46a,0x30703d3a,0xbcfdbcb4
.long 0xbd8cbc00,0xba49bd3a,0x3a498000,0x3d8c3d3a,0xb46abc00,0xbcb43d3a,0x3cb48000,0x346abd3a
.long 0x3d8cbc00,0x3a49bd3a,0xba498000,0xbd8c3d3a,0x346abc00,0x3cb43d3a,0xbcb48000,0xb46abd3a
.long 0x30703c00,0xbd6aba49,0xb955bd3a,0x3c5f346a,0xbda13c00,0x36923a49,0x3cfdbd3a,0xbb2db46a
.long 0xb0703c00,0x3d6aba49,0x3955bd3a,0xbc5f346a,0x3da13c00,0xb6923a49,0xbcfdbd3a,0x3b2db46a
.long 0xbd3abc00,0xbd3abda8,0xb854bc00,0x38548000,0xb854bc00,0xb8543da8,0x3d3abc00,0xbd3a0000
.long 0x3d3abc00,0x3d3abda8,0x3854bc00,0xb8548000,0x3854bc00,0x38543da8,0xbd3abc00,0x3d3a0000
.long 0xb9550000,0xbda1bcb4,0xbb2dbd3a,0x3692b46a,0xbcfd0000,0x30703cb4,0x3c5fbd3a,0xbd6a346a
.long 0x39550000,0x3da1bcb4,0x3b2dbd3a,0xb692b46a,0x3cfd0000,0xb0703cb4,0xbc5fbd3a,0x3d6a346a
.long 0x346a3c00,0xbcb4b854,0xbcb4bda8,0x346ab854,0xbd8c3c00,0x3a493854,0x3a49bda8,0xbd8c3854
.long 0xb46a3c00,0x3cb4b854,0x3cb4bda8,0xb46ab854,0x3d8c3c00,0xba493854,0xba49bda8,0x3d8c3854
.long 0x3c5f3da8,0xb955346a,0xbd6abd3a,0x3070ba49,0xbb2d3da8,0x3cfdb46a,0x3692bd3a,0xbda13a49
.long 0xbc5f3da8,0x3955346a,0x3d6abd3a,0xb070ba49,0x3b2d3da8,0xbcfdb46a,0xb692bd3a,0x3da13a49
.long 0xb854bc00,0x38548000,0x3d3a3c00,0x3d3a3da8,0x3d3abc00,0xbd3a0000,0x38543c00,0x3854bda8
.long 0x3854bc00,0xb8548000,0xbd3a3c00,0xbd3a3da8,0xbd3abc00,0x3d3a0000,0xb8543c00,0xb854bda8
.long 0xb692bc00,0x3b2d346a,0x3da13d3a,0x39553cb4,0x3d6abc00,0xbc5fb46a,0xb0703d3a,0x3cfdbcb4
.long 0x3692bc00,0xbb2d346a,0xbda13d3a,0xb9553cb4,0xbd6abc00,0x3c5fb46a,0x30703d3a,0xbcfdbcb4
.long 0xb46abc00,0x3cb43854,0x3cb43da8,0xb46a3854,0x3d8cbc00,0xba49b854,0xba493da8,0x3d8cb854
.long 0x346abc00,0xbcb43854,0xbcb43da8,0x346a3854,0xbd8cbc00,0x3a49b854,0x3a493da8,0xbd8cb854
.long 0xb070bc00,0x3d6a3a49,0x39553d3a,0xbc5fb46a,0x3da1bc00,0xb692ba49,0xbcfd3d3a,0x3b2d346a
.long 0x3070bc00,0xbd6a3a49,0xb9553d3a,0x3c5fb46a,0xbda1bc00,0x3692ba49,0x3cfd3d3a,0xbb2d346a
.long 0x38543c00,0xb8540000,0xbd3abc00,0xbd3abda8,0xbd3a3c00,0x3d3a8000,0xb854bc00,0xb8543da8
.long 0xb8543c00,0x38540000,0x3d3abc00,0x3d3abda8,0x3d3a3c00,0xbd3a8000,0x3854bc00,0x38543da8
.long 0xb9550000,0xbda1bcb4,0xbb2dbd3a,0x3692b46a,0xbcfd0000,0x30703cb4,0x3c5fbd3a,0xbd6a346a
.long 0x39550000,0x3da1bcb4,0x3b2dbd3a,0xb692b46a,0x3cfd0000,0xb0703cb4,0xbc5fbd3a,0x3d6a346a
.long 0xbd8cbc00,0xba49bd3a,0x3a498000,0x3d8c3d3a,0xb46abc00,0xbcb43d3a,0x3cb48000,0x346abd3a
.long 0x3d8cbc00,0x3a49bd3a,0xba498000,0xbd8c3d3a,0x346abc00,0x3cb43d3a,0xbcb48000,0xb46abd3a
.long 0xbc5fbda8,0x3955b46a,0x3d6a3d3a,0xb0703a49,0x3b2dbda8,0xbcfd346a,0xb6923d3a,0x3da1ba49
.long 0x3c5fbda8,0xb955b46a,0xbd6a3d3a,0x30703a49,0xbb2dbda8,0x3cfd346a,0x36923d3a,0xbda1ba49
.long 0xb854bc00,0x38548000,0x3d3a3c00,0x3d3a3da8,0x3d3abc00,0xbd3a0000,0x38543c00,0x3854bda8
.long 0x3854bc00,0xb8548000,0xbd3a3c00,0xbd3a3da8,0xbd3abc00,0x3d3a0000,0xb8543c00,0xb854bda8
.long 0x3d6a3c00,0x3c5f3d8c,0xb0703854,0xbcfdba49,0x36923c00,0x3b2dbd8c,0xbda13854,0x39553a49
.long 0xbd6a3c00,0xbc5f3d8c,0x30703854,0x3cfdba49,0xb6923c00,0xbb2dbd8c,0x3da13854,0xb9553a49
.long 0x346a3c00,0xbcb4b854,0xbcb4bda8,0x346ab854,0xbd8c3c00,0x3a493854,0x3a49bda8,0xbd8c3854
.long 0xb46a3c00,0x3cb4b854,0x3cb4bda8,0xb46ab854,0x3d8c3c00,0xba493854,0xba49bda8,0x3d8c3854
.long 0xbda1bc00,0xb692bcb4,0x3cfd3854,0x3b2d3d8c,0xb070bc00,0xbd6a3cb4,0x39553854,0x3c5fbd8c
.long 0x3da1bc00,0x3692bcb4,0xbcfd3854,0xbb2d3d8c,0x3070bc00,0x3d6a3cb4,0xb9553854,0xbc5fbd8c
.long 0x38543c00,0xb8540000,0xbd3abc00,0xbd3abda8,0xbd3a3c00,0x3d3a8000,0xb854bc00,0xb8543da8
.long 0xb8543c00,0x38540000,0x3d3abc00,0x3d3abda8,0x3d3a3c00,0xbd3a8000,0x3854bc00,0x38543da8
.long 0xbcfdbda8,0xb070ba49,0x3c5f3854,0x3d6a3d8c,0x3955bda8,0xbda13a49,0x3b2d3854,0x3692bd8c
.long 0x3cfdbda8,0x3070ba49,0xbc5f3854,0xbd6a3d8c,0xb955bda8,0x3da13a49,0xbb2d3854,0xb692bd8c
.long 0x3d8c3c00,0x3a493d3a,0xba490000,0xbd8cbd3a,0x346a3c00,0x3cb4bd3a,0xbcb40000,0xb46a3d3a
.long 0xbd8c3c00,0xba493d3a,0x3a490000,0x3d8cbd3a,0xb46a3c00,0xbcb4bd3a,0x3cb40000,0x346a3d3a
.long 0xbb2d0000,0xbcfdbd8c,0x3692b854,0x3da13cb4,0xbc5f0000,0xb9553d8c,0x3d6ab854,0x3070bcb4
.long 0x3b2d0000,0x3cfdbd8c,0xb692b854,0xbda13cb4,0x3c5f0000,0x39553d8c,0xbd6ab854,0xb070bcb4
.long 0xb854bc00,0x38548000,0x3d3a3c00,0x3d3a3da8,0x3d3abc00,0xbd3a0000,0x38543c00,0x3854bda8
.long 0x3854bc00,0xb8548000,0xbd3a3c00,0xbd3a3da8,0xbd3abc00,0x3d3a0000,0xb8543c00,0xb854bda8
.long 0x36923c00,0xbb2db46a,0xbda1bd3a,0xb955bcb4,0xbd6a3c00,0x3c5f346a,0x3070bd3a,0xbcfd3cb4
.long 0xb6923c00,0x3b2db46a,0x3da1bd3a,0x3955bcb4,0x3d6a3c00,0xbc5f346a,0xb070bd3a,0x3cfd3cb4
.long 0xb46abc00,0x3cb43854,0x3cb43da8,0xb46a3854,0x3d8cbc00,0xba49b854,0xba493da8,0x3d8cb854
.long 0x346abc00,0xbcb43854,0xbcb43da8,0x346a3854,0xbd8cbc00,0x3a49b854,0x3a493da8,0xbd8cb854
.long 0x30703c00,0xbd6aba49,0xb955bd3a,0x3c5f346a,0xbda13c00,0x36923a49,0x3cfdbd3a,0xbb2db46a
.long 0xb0703c00,0x3d6aba49,0x3955bd3a,0xbc5f346a,0x3da13c00,0xb6923a49,0xbcfdbd3a,0x3b2db46a
.long 0x38543c00,0xb8540000,0xbd3abc00,0xbd3abda8,0xbd3a3c00,0x3d3a8000,0xb854bc00,0xb8543da8
.long 0xb8543c00,0x38540000,0x3d3abc00,0x3d3abda8,0x3d3a3c00,0xbd3a8000,0x3854bc00,0x38543da8
.long 0x39558000,0x3da13cb4,0x3b2d3d3a,0xb692346a,0x3cfd8000,0xb070bcb4,0xbc5f3d3a,0x3d6ab46a
.long 0xb9558000,0xbda13cb4,0xbb2d3d3a,0x3692346a,0xbcfd8000,0x3070bcb4,0x3c5f3d3a,0xbd6ab46a
.long 0xbd8cbc00,0xba49bd3a,0x3a498000,0x3d8c3d3a,0xb46abc00,0xbcb43d3a,0x3cb48000,0x346abd3a
.long 0x3d8cbc00,0x3a49bd3a,0xba498000,0xbd8c3d3a,0x346abc00,0x3cb43d3a,0xbcb48000,0xb46abd3a
.long 0x3c5f3da8,0xb955346a,0xbd6abd3a,0x3070ba49,0xbb2d3da8,0x3cfdb46a,0x3692bd3a,0xbda13a49
.long 0xbc5f3da8,0x3955346a,0x3d6abd3a,0xb070ba49,0x3b2d3da8,0xbcfdb46a,0xb692bd3a,0x3da13a49
.long 0xb854bc00,0x38548000,0x3d3a3c00,0x3d3a3da8,0x3d3abc00,0xbd3a0000,0x38543c00,0x3854bda8
.long 0x3854bc00,0xb8548000,0xbd3a3c00,0xbd3a3da8,0xbd3abc00,0x3d3a0000,0xb8543c00,0xb854bda8
.long 0xbd6abc00,0xbc5fbd8c,0x3070b854,0x3cfd3a49,0xb692bc00,0xbb2d3d8c,0x3da1b854,0xb955ba49
.long 0x3d6abc00,0x3c5fbd8c,0xb070b854,0xbcfd3a49,0x3692bc00,0x3b2d3d8c,0xbda1b854,0x3955ba49
.long 0x346a3c00,0xbcb4b854,0xbcb4bda8,0x346ab854,0xbd8c3c00,0x3a493854,0x3a49bda8,0xbd8c3854
.long 0xb46a3c00,0x3cb4b854,0x3cb4bda8,0xb46ab854,0x3d8c3c00,0xba493854,0xba49bda8,0x3d8c3854
.long 0x3da13c00,0x36923cb4,0xbcfdb854,0xbb2dbd8c,0x30703c00,0x3d6abcb4,0xb955b854,0xbc5f3d8c
.long 0xbda13c00,0xb6923cb4,0x3cfdb854,0x3b2dbd8c,0xb0703c00,0xbd6abcb4,0x3955b854,0x3c5f3d8c
.long 0x38543c00,0xb8540000,0xbd3abc00,0xbd3abda8,0xbd3a3c00,0x3d3a8000,0xb854bc00,0xb8543da8
.long 0xb8543c00,0x38540000,0x3d3abc00,0x3d3abda8,0x3d3a3c00,0xbd3a8000,0x3854bc00,0x38543da8
.long 0x3cfd3da8,0x30703a49,0xbc5fb854,0xbd6abd8c,0xb9553da8,0x3da1ba49,0xbb2db854,0xb6923d8c
.long 0xbcfd3da8,0xb0703a49,0x3c5fb854,0x3d6abd8c,0x39553da8,0xbda1ba49,0x3b2db854,0x36923d8c
.long 0x3d8c3c00,0x3a493d3a,0xba490000,0xbd8cbd3a,0x346a3c00,0x3cb4bd3a,0xbcb40000,0xb46a3d3a
.long 0xbd8c3c00,0xba493d3a,0x3a490000,0x3d8cbd3a,0xb46a3c00,0xbcb4bd3a,0x3cb40000,0x346a3d3a
.long 0x3b2d8000,0x3cfd3d8c,0xb6923854,0xbda1bcb4,0x3c5f8000,0x3955bd8c,0xbd6a3854,0xb0703cb4
.long 0xbb2d8000,0xbcfd3d8c,0x36923854,0x3da1bcb4,0xbc5f8000,0xb955bd8c,0x3d6a3854,0x30703cb4
.long 0x3da83c00,0x3c00,0xbda8bc00,0x8000bc00,0x3c00,0x3da8bc00,0x8000bc00,0xbda83c00
.long 0xbda83c00,0x80003c00,0x3da8bc00,0xbc00,0x80003c00,0xbda8bc00,0xbc00,0x3da83c00
.long 0x3da13c00,0xb6923a49,0xbcfdbd3a,0x3b2db46a,0xb0703c00,0x3d6aba49,0x3955bd3a,0xbc5f346a
.long 0xbda13c00,0x36923a49,0x3cfdbd3a,0xbb2db46a,0x30703c00,0xbd6aba49,0xb955bd3a,0x3c5f346a
.long 0x3d8c3c00,0xba493854,0xba49bda8,0x3d8c3854,0xb46a3c00,0x3cb4b854,0x3cb4bda8,0xb46ab854
.long 0xbd8c3c00,0x3a493854,0x3a49bda8,0xbd8c3854,0x346a3c00,0xbcb4b854,0xbcb4bda8,0x346ab854
.long 0x3d6a3c00,0xbc5f346a,0xb070bd3a,0x3cfd3cb4,0xb6923c00,0x3b2db46a,0x3da1bd3a,0x3955bcb4
.long 0xbd6a3c00,0x3c5f346a,0x3070bd3a,0xbcfd3cb4,0x36923c00,0xbb2db46a,0xbda1bd3a,0xb955bcb4
.long 0x3da83c00,0x3c00,0xbda8bc00,0x8000bc00,0x3c00,0x3da8bc00,0x8000bc00,0xbda83c00
.long 0xbda83c00,0x80003c00,0x3da8bc00,0xbc00,0x80003c00,0xbda8bc00,0xbc00,0x3da83c00
.long 0x3b2d3da8,0xbcfdb46a,0xb692bd3a,0x3da13a49,0xbc5f3da8,0x3955346a,0x3d6abd3a,0xb070ba49
.long 0xbb2d3da8,0x3cfdb46a,0x3692bd3a,0xbda13a49,0x3c5f3da8,0xb955346a,0xbd6abd3a,0x3070ba49
.long 0xb46a3c00,0xbcb4bd3a,0x3cb48000,0x346a3d3a,0xbd8c3c00,0xba493d3a,0x3a498000,0x3d8cbd3a
.long 0x346a3c00,0x3cb4bd3a,0xbcb48000,0xb46a3d3a,0x3d8c3c00,0x3a493d3a,0xba498000,0xbd8cbd3a
.long 0xbcfd0000,0x3070bcb4,0x3c5f3d3a,0xbd6ab46a,0xb9550000,0xbda13cb4,0xbb2d3d3a,0x3692346a
.long 0x3cfd0000,0xb070bcb4,0xbc5f3d3a,0x3d6ab46a,0x39550000,0x3da13cb4,0x3b2d3d3a,0xb692346a
.long 0x3da83c00,0x3c00,0xbda8bc00,0x8000bc00,0x3c00,0x3da8bc00,0x8000bc00,0xbda83c00
.long 0xbda83c00,0x80003c00,0x3da8bc00,0xbc00,0x80003c00,0xbda8bc00,0xbc00,0x3da83c00
.long 0xb0703c00,0xbd6abcb4,0x3955b854,0x3c5f3d8c,0xbda13c00,0xb6923cb4,0x3cfdb854,0x3b2dbd8c
.long 0x30703c00,0x3d6abcb4,0xb955b854,0xbc5f3d8c,0x3da13c00,0x36923cb4,0xbcfdb854,0xbb2dbd8c
.long 0xbd8cbc00,0x3a49b854,0x3a493da8,0xbd8cb854,0x346abc00,0xbcb43854,0xbcb43da8,0x346a3854
.long 0x3d8cbc00,0xba49b854,0xba493da8,0x3d8cb854,0xb46abc00,0x3cb43854,0x3cb43da8,0xb46a3854
.long 0x3692bc00,0x3b2d3d8c,0xbda1b854,0x3955ba49,0x3d6abc00,0x3c5fbd8c,0xb070b854,0xbcfd3a49
.long 0xb692bc00,0xbb2d3d8c,0x3da1b854,0xb955ba49,0xbd6abc00,0xbc5fbd8c,0x3070b854,0x3cfd3a49
.long 0x3da83c00,0x3c00,0xbda8bc00,0x8000bc00,0x3c00,0x3da8bc00,0x8000bc00,0xbda83c00
.long 0xbda83c00,0x80003c00,0x3da8bc00,0xbc00,0x80003c00,0xbda8bc00,0xbc00,0x3da83c00
.long 0xbc5f0000,0xb955bd8c,0x3d6a3854,0x30703cb4,0xbb2d0000,0xbcfd3d8c,0x36923854,0x3da1bcb4
.long 0x3c5f0000,0x3955bd8c,0xbd6a3854,0xb0703cb4,0x3b2d0000,0x3cfd3d8c,0xb6923854,0xbda1bcb4
.long 0x346abc00,0x3cb43d3a,0xbcb40000,0xb46abd3a,0x3d8cbc00,0x3a49bd3a,0xba490000,0xbd8c3d3a
.long 0xb46abc00,0xbcb43d3a,0x3cb40000,0x346abd3a,0xbd8cbc00,0xba49bd3a,0x3a490000,0x3d8c3d3a
.long 0x39553da8,0xbda1ba49,0x3b2db854,0x36923d8c,0xbcfd3da8,0xb0703a49,0x3c5fb854,0x3d6abd8c
.long 0xb9553da8,0x3da1ba49,0xbb2db854,0xb6923d8c,0x3cfd3da8,0x30703a49,0xbc5fb854,0xbd6abd8c
.long 0x3da83c00,0x3c00,0xbda8bc00,0x8000bc00,0x3c00,0x3da8bc00,0x8000bc00,0xbda83c00
.long 0xbda83c00,0x80003c00,0x3da8bc00,0xbc00,0x80003c00,0xbda8bc00,0xbc00,0x3da83c00
.long 0xbda1bc00,0x3692ba49,0x3cfd3d3a,0xbb2d346a,0x3070bc00,0xbd6a3a49,0xb9553d3a,0x3c5fb46a
.long 0x3da1bc00,0xb692ba49,0xbcfd3d3a,0x3b2d346a,0xb070bc00,0x3d6a3a49,0x39553d3a,0xbc5fb46a
.long 0x3d8c3c00,0xba493854,0xba49bda8,0x3d8c3854,0xb46a3c00,0x3cb4b854,0x3cb4bda8,0xb46ab854
.long 0xbd8c3c00,0x3a493854,0x3a49bda8,0xbd8c3854,0x346a3c00,0xbcb4b854,0xbcb4bda8,0x346ab854
.long 0xbd6abc00,0x3c5fb46a,0x30703d3a,0xbcfdbcb4,0x3692bc00,0xbb2d346a,0xbda13d3a,0xb9553cb4
.long 0x3d6abc00,0xbc5fb46a,0xb0703d3a,0x3cfdbcb4,0xb692bc00,0x3b2d346a,0x3da13d3a,0x39553cb4
.long 0x3da83c00,0x3c00,0xbda8bc00,0x8000bc00,0x3c00,0x3da8bc00,0x8000bc00,0xbda83c00
.long 0xbda83c00,0x80003c00,0x3da8bc00,0xbc00,0x80003c00,0xbda8bc00,0xbc00,0x3da83c00
.long 0xbb2dbda8,0x3cfd346a,0x36923d3a,0xbda1ba49,0x3c5fbda8,0xb955b46a,0xbd6a3d3a,0x30703a49
.long 0x3b2dbda8,0xbcfd346a,0xb6923d3a,0x3da1ba49,0xbc5fbda8,0x3955b46a,0x3d6a3d3a,0xb0703a49
.long 0xb46a3c00,0xbcb4bd3a,0x3cb48000,0x346a3d3a,0xbd8c3c00,0xba493d3a,0x3a498000,0x3d8cbd3a
.long 0x346a3c00,0x3cb4bd3a,0xbcb48000,0xb46a3d3a,0x3d8c3c00,0x3a493d3a,0xba498000,0xbd8cbd3a
.long 0x3cfd8000,0xb0703cb4,0xbc5fbd3a,0x3d6a346a,0x39558000,0x3da1bcb4,0x3b2dbd3a,0xb692b46a
.long 0xbcfd8000,0x30703cb4,0x3c5fbd3a,0xbd6a346a,0xb9558000,0xbda1bcb4,0xbb2dbd3a,0x3692b46a
.long 0x3da83c00,0x3c00,0xbda8bc00,0x8000bc00,0x3c00,0x3da8bc00,0x8000bc00,0xbda83c00
.long 0xbda83c00,0x80003c00,0x3da8bc00,0xbc00,0x80003c00,0xbda8bc00,0xbc00,0x3da83c00
.long 0x3070bc00,0x3d6a3cb4,0xb9553854,0xbc5fbd8c,0x3da1bc00,0x3692bcb4,0xbcfd3854,0xbb2d3d8c
.long 0xb070bc00,0xbd6a3cb4,0x39553854,0x3c5fbd8c,0xbda1bc00,0xb692bcb4,0x3cfd3854,0x3b2d3d8c
.long 0xbd8cbc00,0x3a49b854,0x3a493da8,0xbd8cb854,0x346abc00,0xbcb43854,0xbcb43da8,0x346a3854
.long 0x3d8cbc00,0xba49b854,0xba493da8,0x3d8cb854,0xb46abc00,0x3cb43854,0x3cb43da8,0xb46a3854
.long 0xb6923c00,0xbb2dbd8c,0x3da13854,0xb9553a49,0xbd6a3c00,0xbc5f3d8c,0x30703854,0x3cfdba49
.long 0x36923c00,0x3b2dbd8c,0xbda13854,0x39553a49,0x3d6a3c00,0x3c5f3d8c,0xb0703854,0xbcfdba49
.long 0x3da83c00,0x3c00,0xbda8bc00,0x8000bc00,0x3c00,0x3da8bc00,0x8000bc00,0xbda83c00
.long 0xbda83c00,0x80003c00,0x3da8bc00,0xbc00,0x80003c00,0xbda8bc00,0xbc00,0x3da83c00
.long 0x3c5f8000,0x39553d8c,0xbd6ab854,0xb070bcb4,0x3b2d8000,0x3cfdbd8c,0xb692b854,0xbda13cb4
.long 0xbc5f8000,0xb9553d8c,0x3d6ab854,0x3070bcb4,0xbb2d8000,0xbcfdbd8c,0x3692b854,0x3da13cb4
.long 0x346abc00,0x3cb43d3a,0xbcb40000,0xb46abd3a,0x3d8cbc00,0x3a49bd3a,0xba490000,0xbd8c3d3a
.long 0xb46abc00,0xbcb43d3a,0x3cb40000,0x346abd3a,0xbd8cbc00,0xba49bd3a,0x3a490000,0x3d8c3d3a
.long 0xb955bda8,0x3da13a49,0xbb2d3854,0xb692bd8c,0x3cfdbda8,0x3070ba49,0xbc5f3854,0xbd6a3d8c
.long 0x3955bda8,0xbda13a49,0x3b2d3854,0x3692bd8c,0xbcfdbda8,0xb070ba49,0x3c5f3854,0x3d6a3d8c
.long 0x8000bc00,0x3da83c00,0x3c00,0xbda8bc00,0x3da8bc00,0x8000bc00,0xbda83c00,0x3c00
.long 0xbc00,0xbda83c00,0x80003c00,0x3da8bc00,0xbda8bc00,0xbc00,0x3da83c00,0x80003c00
.long 0x3070bc00,0x3d6a3cb4,0xb9553854,0xbc5fbd8c,0x3da1bc00,0x3692bcb4,0xbcfd3854,0xbb2d3d8c
.long 0xb070bc00,0xbd6a3cb4,0x39553854,0x3c5fbd8c,0xbda1bc00,0xb692bcb4,0x3cfd3854,0x3b2d3d8c
.long 0x346abc00,0x3cb43d3a,0xbcb40000,0xb46abd3a,0x3d8cbc00,0x3a49bd3a,0xba490000,0xbd8c3d3a
.long 0xb46abc00,0xbcb43d3a,0x3cb40000,0x346abd3a,0xbd8cbc00,0xba49bd3a,0x3a490000,0x3d8c3d3a
.long 0x3692bc00,0x3b2d3d8c,0xbda1b854,0x3955ba49,0x3d6abc00,0x3c5fbd8c,0xb070b854,0xbcfd3a49
.long 0xb692bc00,0xbb2d3d8c,0x3da1b854,0xb955ba49,0xbd6abc00,0xbc5fbd8c,0x3070b854,0x3cfd3a49
.long 0x8000bc00,0x3da83c00,0x3c00,0xbda8bc00,0x3da8bc00,0x8000bc00,0xbda83c00,0x3c00
.long 0xbc00,0xbda83c00,0x80003c00,0x3da8bc00,0xbda8bc00,0xbc00,0x3da83c00,0x80003c00
.long 0x3c5f8000,0x39553d8c,0xbd6ab854,0xb070bcb4,0x3b2d8000,0x3cfdbd8c,0xb692b854,0xbda13cb4
.long 0xbc5f8000,0xb9553d8c,0x3d6ab854,0x3070bcb4,0xbb2d8000,0xbcfdbd8c,0x3692b854,0x3da13cb4
.long 0x3d8c3c00,0xba493854,0xba49bda8,0x3d8c3854,0xb46a3c00,0x3cb4b854,0x3cb4bda8,0xb46ab854
.long 0xbd8c3c00,0x3a493854,0x3a49bda8,0xbd8c3854,0x346a3c00,0xbcb4b854,0xbcb4bda8,0x346ab854
.long 0x39553da8,0xbda1ba49,0x3b2db854,0x36923d8c,0xbcfd3da8,0xb0703a49,0x3c5fb854,0x3d6abd8c
.long 0xb9553da8,0x3da1ba49,0xbb2db854,0xb6923d8c,0x3cfd3da8,0x30703a49,0xbc5fb854,0xbd6abd8c
.long 0x8000bc00,0x3da83c00,0x3c00,0xbda8bc00,0x3da8bc00,0x8000bc00,0xbda83c00,0x3c00
.long 0xbc00,0xbda83c00,0x80003c00,0x3da8bc00,0xbda8bc00,0xbc00,0x3da83c00,0x80003c00
.long 0x3da13c00,0xb6923a49,0xbcfdbd3a,0x3b2db46a,0xb0703c00,0x3d6aba49,0x3955bd3a,0xbc5f346a
.long 0xbda13c00,0x36923a49,0x3cfdbd3a,0xbb2db46a,0x30703c00,0xbd6aba49,0xb955bd3a,0x3c5f346a
.long 0xb46a3c00,0xbcb4bd3a,0x3cb48000,0x346a3d3a,0xbd8c3c00,0xba493d3a,0x3a498000,0x3d8cbd3a
.long 0x346a3c00,0x3cb4bd3a,0xbcb48000,0xb46a3d3a,0x3d8c3c00,0x3a493d3a,0xba498000,0xbd8cbd3a
.long 0xbd6abc00,0x3c5fb46a,0x30703d3a,0xbcfdbcb4,0x3692bc00,0xbb2d346a,0xbda13d3a,0xb9553cb4
.long 0x3d6abc00,0xbc5fb46a,0xb0703d3a,0x3cfdbcb4,0xb692bc00,0x3b2d346a,0x3da13d3a,0x39553cb4
.long 0x8000bc00,0x3da83c00,0x3c00,0xbda8bc00,0x3da8bc00,0x8000bc00,0xbda83c00,0x3c00
.long 0xbc00,0xbda83c00,0x80003c00,0x3da8bc00,0xbda8bc00,0xbc00,0x3da83c00,0x80003c00
.long 0x3b2d3da8,0xbcfdb46a,0xb692bd3a,0x3da13a49,0xbc5f3da8,0x3955346a,0x3d6abd3a,0xb070ba49
.long 0xbb2d3da8,0x3cfdb46a,0x3692bd3a,0xbda13a49,0x3c5f3da8,0xb955346a,0xbd6abd3a,0x3070ba49
.long 0xbd8cbc00,0x3a49b854,0x3a493da8,0xbd8cb854,0x346abc00,0xbcb43854,0xbcb43da8,0x346a3854
.long 0x3d8cbc00,0xba49b854,0xba493da8,0x3d8cb854,0xb46abc00,0x3cb43854,0x3cb43da8,0xb46a3854
.long 0x3cfd8000,0xb0703cb4,0xbc5fbd3a,0x3d6a346a,0x39558000,0x3da1bcb4,0x3b2dbd3a,0xb692b46a
.long 0xbcfd8000,0x30703cb4,0x3c5fbd3a,0xbd6a346a,0xb9558000,0xbda1bcb4,0xbb2dbd3a,0x3692b46a
.long 0x8000bc00,0x3da83c00,0x3c00,0xbda8bc00,0x3da8bc00,0x8000bc00,0xbda83c00,0x3c00
.long 0xbc00,0xbda83c00,0x80003c00,0x3da8bc00,0xbda8bc00,0xbc00,0x3da83c00,0x80003c00
.long 0xb0703c00,0xbd6abcb4,0x3955b854,0x3c5f3d8c,0xbda13c00,0xb6923cb4,0x3cfdb854,0x3b2dbd8c
.long 0x30703c00,0x3d6abcb4,0xb955b854,0xbc5f3d8c,0x3da13c00,0x36923cb4,0xbcfdb854,0xbb2dbd8c
.long 0x346abc00,0x3cb43d3a,0xbcb40000,0xb46abd3a,0x3d8cbc00,0x3a49bd3a,0xba490000,0xbd8c3d3a
.long 0xb46abc00,0xbcb43d3a,0x3cb40000,0x346abd3a,0xbd8cbc00,0xba49bd3a,0x3a490000,0x3d8c3d3a
.long 0xb6923c00,0xbb2dbd8c,0x3da13854,0xb9553a49,0xbd6a3c00,0xbc5f3d8c,0x30703854,0x3cfdba49
.long 0x36923c00,0x3b2dbd8c,0xbda13854,0x39553a49,0x3d6a3c00,0x3c5f3d8c,0xb0703854,0xbcfdba49
.long 0x8000bc00,0x3da83c00,0x3c00,0xbda8bc00,0x3da8bc00,0x8000bc00,0xbda83c00,0x3c00
.long 0xbc00,0xbda83c00,0x80003c00,0x3da8bc00,0xbda8bc00,0xbc00,0x3da83c00,0x80003c00
.long 0xbc5f0000,0xb955bd8c,0x3d6a3854,0x30703cb4,0xbb2d0000,0xbcfd3d8c,0x36923854,0x3da1bcb4
.long 0x3c5f0000,0x3955bd8c,0xbd6a3854,0xb0703cb4,0x3b2d0000,0x3cfd3d8c,0xb6923854,0xbda1bcb4
.long 0x3d8c3c00,0xba493854,0xba49bda8,0x3d8c3854,0xb46a3c00,0x3cb4b854,0x3cb4bda8,0xb46ab854
.long 0xbd8c3c00,0x3a493854,0x3a49bda8,0xbd8c3854,0x346a3c00,0xbcb4b854,0xbcb4bda8,0x346ab854
.long 0xb955bda8,0x3da13a49,0xbb2d3854,0xb692bd8c,0x3cfdbda8,0x3070ba49,0xbc5f3854,0xbd6a3d8c
.long 0x3955bda8,0xbda13a49,0x3b2d3854,0x3692bd8c,0xbcfdbda8,0xb070ba49,0x3c5f3854,0x3d6a3d8c
.long 0x8000bc00,0x3da83c00,0x3c00,0xbda8bc00,0x3da8bc00,0x8000bc00,0xbda83c00,0x3c00
.long 0xbc00,0xbda83c00,0x80003c00,0x3da8bc00,0xbda8bc00,0xbc00,0x3da83c00,0x80003c00
.long 0xbda1bc00,0x3692ba49,0x3cfd3d3a,0xbb2d346a,0x3070bc00,0xbd6a3a49,0xb9553d3a,0x3c5fb46a
.long 0x3da1bc00,0xb692ba49,0xbcfd3d3a,0x3b2d346a,0xb070bc00,0x3d6a3a49,0x39553d3a,0xbc5fb46a
.long 0xb46a3c00,0xbcb4bd3a,0x3cb48000,0x346a3d3a,0xbd8c3c00,0xba493d3a,0x3a498000,0x3d8cbd3a
.long 0x346a3c00,0x3cb4bd3a,0xbcb48000,0xb46a3d3a,0x3d8c3c00,0x3a493d3a,0xba498000,0xbd8cbd3a
.long 0x3d6a3c00,0xbc5f346a,0xb070bd3a,0x3cfd3cb4,0xb6923c00,0x3b2db46a,0x3da1bd3a,0x3955bcb4
.long 0xbd6a3c00,0x3c5f346a,0x3070bd3a,0xbcfd3cb4,0x36923c00,0xbb2db46a,0xbda1bd3a,0xb955bcb4
.long 0x8000bc00,0x3da83c00,0x3c00,0xbda8bc00,0x3da8bc00,0x8000bc00,0xbda83c00,0x3c00
.long 0xbc00,0xbda83c00,0x80003c00,0x3da8bc00,0xbda8bc00,0xbc00,0x3da83c00,0x80003c00
.long 0xbb2dbda8,0x3cfd346a,0x36923d3a,0xbda1ba49,0x3c5fbda8,0xb955b46a,0xbd6a3d3a,0x30703a49
.long 0x3b2dbda8,0xbcfd346a,0xb6923d3a,0x3da1ba49,0xbc5fbda8,0x3955b46a,0x3d6a3d3a,0xb0703a49
.long 0xbd8cbc00,0x3a49b854,0x3a493da8,0xbd8cb854,0x346abc00,0xbcb43854,0xbcb43da8,0x346a3854
.long 0x3d8cbc00,0xba49b854,0xba493da8,0x3d8cb854,0xb46abc00,0x3cb43854,0x3cb43da8,0xb46a3854
.long 0xbcfd0000,0x3070bcb4,0x3c5f3d3a,0xbd6ab46a,0xb9550000,0xbda13cb4,0xbb2d3d3a,0x3692346a
.long 0x3cfd0000,0xb070bcb4,0xbc5f3d3a,0x3d6ab46a,0x39550000,0x3da13cb4,0x3b2d3d3a,0xb692346a
.long 0x3c003c00,0x3c003c00,0x3c003c00,0x3c003c00,0x3c00,0xb23e3bd9,0xb61f3b64,0xb8723aa7
.long 0xbc003c00,0xbb643b64,0xb9a839a8,0xb61f361f,0x80003c00,0x38723aa7,0x3b64361f,0x3bd9b23e
.long 0x3c003c00,0x0,0xbc00bc00,0x80008000,0x3c00,0xbbd9b23e,0x361fbb64,0x3aa73872
.long 0xbc003c00,0x361fb61f,0x39a8b9a8,0xbb643b64,0x80003c00,0x3aa7b872,0xbb64b61f,0x323e3bd9
.long 0x3c003c00,0xbc00bc00,0x3c003c00,0xbc00bc00,0x3c00,0x323ebbd9,0xb61f3b64,0x3872baa7
.long 0xbc003c00,0x3b64bb64,0xb9a839a8,0x361fb61f,0x80003c00,0xb872baa7,0x3b64361f,0xbbd9323e
.long 0x3c003c00,0x80008000,0xbc00bc00,0x0,0x3c00,0x3bd9323e,0x361fbb64,0xbaa7b872
.long 0xbc003c00,0xb61f361f,0x39a8b9a8,0x3b64bb64,0x80003c00,0xbaa73872,0xbb64b61f,0xb23ebbd9
.long 0x3c003c00,0x3c003c00,0x3c003c00,0x3c003c00,0xb9a839a8,0xbaa73872,0xbb64361f,0xbbd9323e
.long 0x80000000,0x361fb61f,0x39a8b9a8,0x3b64bb64,0x39a8b9a8,0x323ebbd9,0xb61fbb64,0xbaa7b872
.long 0x3c003c00,0x0,0xbc00bc00,0x80008000,0xb9a839a8,0xb872baa7,0x3b64b61f,0x323e3bd9
.long 0x80000000,0x3b64bb64,0xb9a839a8,0xb61f361f,0x39a8b9a8,0xbbd9b23e,0x361f3b64,0x3872baa7
.long 0x3c003c00,0xbc00bc00,0x3c003c00,0xbc00bc00,0xb9a839a8,0x3aa7b872,0xbb64361f,0x3bd9b23e
.long 0x80000000,0xb61f361f,0x39a8b9a8,0xbb643b64,0x39a8b9a8,0xb23e3bd9,0xb61fbb64,0x3aa73872
.long 0x3c003c00,0x80008000,0xbc00bc00,0x0,0xb9a839a8,0x38723aa7,0x3b64b61f,0xb23ebbd9
.long 0x80000000,0xbb643b64,0xb9a839a8,0x361fb61f,0x39a8b9a8,0x3bd9323e,0x361f3b64,0xb8723aa7
.long 0x3c003c00,0x3c003c00,0x3c003c00,0x3c003c00,0x8000bc00,0x323ebbd9,0x361fbb64,0x3872baa7
.long 0xbc003c00,0xbb643b64,0xb9a839a8,0xb61f361f,0xbc00,0xb872baa7,0xbb64b61f,0xbbd9323e
.long 0x3c003c00,0x0,0xbc00bc00,0x80008000,0x8000bc00,0x3bd9323e,0xb61f3b64,0xbaa7b872
.long 0xbc003c00,0x361fb61f,0x39a8b9a8,0xbb643b64,0xbc00,0xbaa73872,0x3b64361f,0xb23ebbd9
.long 0x3c003c00,0xbc00bc00,0x3c003c00,0xbc00bc00,0x8000bc00,0xb23e3bd9,0x361fbb64,0xb8723aa7
.long 0xbc003c00,0x3b64bb64,0xb9a839a8,0x361fb61f,0xbc00,0x38723aa7,0xbb64b61f,0x3bd9b23e
.long 0x3c003c00,0x80008000,0xbc00bc00,0x0,0x8000bc00,0xbbd9b23e,0xb61f3b64,0x3aa73872
.long 0xbc003c00,0xb61f361f,0x39a8b9a8,0x3b64bb64,0xbc00,0x3aa7b872,0x3b64361f,0x323e3bd9
.long 0x3c003c00,0x3c003c00,0x3c003c00,0x3c003c00,0x39a8b9a8,0x3aa7b872,0x3b64b61f,0x3bd9b23e
.long 0x80000000,0x361fb61f,0x39a8b9a8,0x3b64bb64,0xb9a839a8,0xb23e3bd9,0x361f3b64,0x3aa73872
.long 0x3c003c00,0x0,0xbc00bc00,0x80008000,0x39a8b9a8,0x38723aa7,0xbb64361f,0xb23ebbd9
.long 0x80000000,0x3b64bb64,0xb9a839a8,0xb61f361f,0xb9a839a8,0x3bd9323e,0xb61fbb64,0xb8723aa7
.long 0x3c003c00,0xbc00bc00,0x3c003c00,0xbc00bc00,0x39a8b9a8,0xbaa73872,0x3b64b61f,0xbbd9323e
.long 0x80000000,0xb61f361f,0x39a8b9a8,0xbb643b64,0xb9a839a8,0x323ebbd9,0x361f3b64,0xbaa7b872
.long 0x3c003c00,0x80008000,0xbc00bc00,0x0,0x39a8b9a8,0xb872baa7,0xbb64361f,0x323e3bd9
.long 0x80000000,0xbb643b64,0xb9a839a8,0x361fb61f,0xb9a839a8,0xbbd9b23e,0xb61fbb64,0x3872baa7
.long 0x80008000,0x80008000,0x80008000,0x80008000,0xbc008000,0xbbd9b23e,0xbb64b61f,0xbaa7b872
.long 0x80008000,0x361fb61f,0x39a8b9a8,0x3b64bb64,0x3c008000,0x3aa7b872,0x361fbb64,0xb23ebbd9
.long 0x80008000,0xbc00bc00,0x80008000,0x3c003c00,0xbc008000,0x323ebbd9,0x3b64361f,0xb8723aa7
.long 0x80008000,0x3b64bb64,0xb9a839a8,0xb61f361f,0x3c008000,0xb872baa7,0xb61f3b64,0x3bd9b23e
.long 0x80008000,0x80008000,0x80008000,0x80008000,0xbc008000,0x3bd9323e,0xbb64b61f,0x3aa73872
.long 0x80008000,0xb61f361f,0x39a8b9a8,0xbb643b64,0x3c008000,0xbaa73872,0x361fbb64,0x323e3bd9
.long 0x80008000,0x3c003c00,0x80008000,0xbc00bc00,0xbc008000,0xb23e3bd9,0x3b64361f,0x3872baa7
.long 0x80008000,0xbb643b64,0xb9a839a8,0x361fb61f,0x3c008000,0x38723aa7,0xb61f3b64,0xbbd9323e
.long 0x80008000,0x80008000,0x80008000,0x80008000,0xb9a8b9a8,0xb872baa7,0xb61fbb64,0xb23ebbd9
.long 0x3c00bc00,0x3b64bb64,0x39a8b9a8,0x361fb61f,0xb9a8b9a8,0xbbd9b23e,0xbb64361f,0xb8723aa7
.long 0x80008000,0xbc00bc00,0x80008000,0x3c003c00,0xb9a8b9a8,0x3aa7b872,0x361f3b64,0xbbd9323e
.long 0x3c00bc00,0xb61f361f,0xb9a839a8,0x3b64bb64,0xb9a8b9a8,0xb23e3bd9,0x3b64b61f,0xbaa7b872
.long 0x80008000,0x80008000,0x80008000,0x80008000,0xb9a8b9a8,0x38723aa7,0xb61fbb64,0x323e3bd9
.long 0x3c00bc00,0xbb643b64,0x39a8b9a8,0xb61f361f,0xb9a8b9a8,0x3bd9323e,0xbb64361f,0x3872baa7
.long 0x80008000,0x3c003c00,0x80008000,0xbc00bc00,0xb9a8b9a8,0xbaa73872,0x361f3b64,0x3bd9b23e
.long 0x3c00bc00,0x361fb61f,0xb9a839a8,0xbb643b64,0xb9a8b9a8,0x323ebbd9,0x3b64b61f,0x3aa73872
.long 0x80008000,0x80008000,0x80008000,0x80008000,0x3c008000,0x3bd9323e,0x3b64361f,0x3aa73872
.long 0x80008000,0x361fb61f,0x39a8b9a8,0x3b64bb64,0xbc008000,0xbaa73872,0xb61f3b64,0x323e3bd9
.long 0x80008000,0xbc00bc00,0x80008000,0x3c003c00,0x3c008000,0xb23e3bd9,0xbb64b61f,0x3872baa7
.long 0x80008000,0x3b64bb64,0xb9a839a8,0xb61f361f,0xbc008000,0x38723aa7,0x361fbb64,0xbbd9323e
.long 0x80008000,0x80008000,0x80008000,0x80008000,0x3c008000,0xbbd9b23e,0x3b64361f,0xbaa7b872
.long 0x80008000,0xb61f361f,0x39a8b9a8,0xbb643b64,0xbc008000,0x3aa7b872,0xb61f3b64,0xb23ebbd9
.long 0x80008000,0x3c003c00,0x80008000,0xbc00bc00,0x3c008000,0x323ebbd9,0xbb64b61f,0xb8723aa7
.long 0x80008000,0xbb643b64,0xb9a839a8,0x361fb61f,0xbc008000,0xb872baa7,0x361fbb64,0x3bd9b23e
.long 0x80008000,0x80008000,0x80008000,0x80008000,0x39a839a8,0x38723aa7,0x361f3b64,0x323e3bd9
.long 0x3c00bc00,0x3b64bb64,0x39a8b9a8,0x361fb61f,0x39a839a8,0x3bd9323e,0x3b64b61f,0x3872baa7
.long 0x80008000,0xbc00bc00,0x80008000,0x3c003c00,0x39a839a8,0xbaa73872,0xb61fbb64,0x3bd9b23e
.long 0x3c00bc00,0xb61f361f,0xb9a839a8,0x3b64bb64,0x39a839a8,0x323ebbd9,0xbb64361f,0x3aa73872
.long 0x80008000,0x80008000,0x80008000,0x80008000,0x39a839a8,0xb872baa7,0x361f3b64,0xb23ebbd9
.long 0x3c00bc00,0xbb643b64,0x39a8b9a8,0xb61f361f,0x39a839a8,0xbbd9b23e,0x3b64b61f,0xb8723aa7
.long 0x80008000,0x3c003c00,0x80008000,0xbc00bc00,0x39a839a8,0x3aa7b872,0xb61fbb64,0xbbd9323e
.long 0x3c00bc00,0x361fb61f,0xb9a839a8,0xbb643b64,0x39a839a8,0xb23e3bd9,0xbb64361f,0xbaa7b872
.long 0x3c003c00,0x39a839a8,0x0,0xb9a8b9a8,0x3c00,0xbaa73872,0xbb64b61f,0xb23ebbd9
.long 0xbc003c00,0xb61f361f,0x39a8b9a8,0x3b64bb64,0x80003c00,0x3bd9323e,0x361fbb64,0xbaa7b872
.long 0x3c003c00,0xb9a8b9a8,0x80008000,0x39a839a8,0x3c00,0xb872baa7,0x3b64361f,0xbbd9323e
.long 0xbc003c00,0x3b64bb64,0xb9a839a8,0x361fb61f,0x80003c00,0x323ebbd9,0xb61f3b64,0x3872baa7
.long 0x3c003c00,0xb9a8b9a8,0x0,0x39a839a8,0x3c00,0x3aa7b872,0xbb64b61f,0x323e3bd9
.long 0xbc003c00,0x361fb61f,0x39a8b9a8,0xbb643b64,0x80003c00,0xbbd9b23e,0x361fbb64,0x3aa73872
.long 0x3c003c00,0x39a839a8,0x80008000,0xb9a8b9a8,0x3c00,0x38723aa7,0x3b64361f,0x3bd9b23e
.long 0xbc003c00,0xbb643b64,0xb9a839a8,0xb61f361f,0x80003c00,0xb23e3bd9,0xb61f3b64,0xb8723aa7
.long 0xbc00bc00,0xb9a8b9a8,0x80008000,0x39a839a8,0x39a8b9a8,0x3bd9323e,0x361f3b64,0xb8723aa7
.long 0x8000,0xbb643b64,0xb9a839a8,0x361fb61f,0xb9a839a8,0x38723aa7,0x3b64b61f,0xb23ebbd9
.long 0xbc00bc00,0x39a839a8,0x0,0xb9a8b9a8,0x39a8b9a8,0xb23e3bd9,0xb61fbb64,0x3aa73872
.long 0x8000,0xb61f361f,0x39a8b9a8,0xbb643b64,0xb9a839a8,0x3aa7b872,0xbb64361f,0x3bd9b23e
.long 0xbc00bc00,0x39a839a8,0x80008000,0xb9a8b9a8,0x39a8b9a8,0xbbd9b23e,0x361f3b64,0x3872baa7
.long 0x8000,0x3b64bb64,0xb9a839a8,0xb61f361f,0xb9a839a8,0xb872baa7,0x3b64b61f,0x323e3bd9
.long 0xbc00bc00,0xb9a8b9a8,0x0,0x39a839a8,0x39a8b9a8,0x323ebbd9,0xb61fbb64,0xbaa7b872
.long 0x8000,0x361fb61f,0x39a8b9a8,0x3b64bb64,0xb9a839a8,0xbaa73872,0xbb64361f,0xbbd9323e
.long 0x3c003c00,0x39a839a8,0x0,0xb9a8b9a8,0x8000bc00,0x3aa7b872,0x3b64361f,0x323e3bd9
.long 0xbc003c00,0xb61f361f,0x39a8b9a8,0x3b64bb64,0xbc00,0xbbd9b23e,0xb61f3b64,0x3aa73872
.long 0x3c003c00,0xb9a8b9a8,0x80008000,0x39a839a8,0x8000bc00,0x38723aa7,0xbb64b61f,0x3bd9b23e
.long 0xbc003c00,0x3b64bb64,0xb9a839a8,0x361fb61f,0xbc00,0xb23e3bd9,0x361fbb64,0xb8723aa7
.long 0x3c003c00,0xb9a8b9a8,0x0,0x39a839a8,0x8000bc00,0xbaa73872,0x3b64361f,0xb23ebbd9
.long 0xbc003c00,0x361fb61f,0x39a8b9a8,0xbb643b64,0xbc00,0x3bd9323e,0xb61f3b64,0xbaa7b872
.long 0x3c003c00,0x39a839a8,0x80008000,0xb9a8b9a8,0x8000bc00,0xb872baa7,0xbb64b61f,0xbbd9323e
.long 0xbc003c00,0xbb643b64,0xb9a839a8,0xb61f361f,0xbc00,0x323ebbd9,0x361fbb64,0x3872baa7
.long 0xbc00bc00,0xb9a8b9a8,0x80008000,0x39a839a8,0xb9a839a8,0xbbd9b23e,0xb61fbb64,0x3872baa7
.long 0x8000,0xbb643b64,0xb9a839a8,0x361fb61f,0x39a8b9a8,0xb872baa7,0xbb64361f,0x323e3bd9
.long 0xbc00bc00,0x39a839a8,0x0,0xb9a8b9a8,0xb9a839a8,0x323ebbd9,0x361f3b64,0xbaa7b872
.long 0x8000,0xb61f361f,0x39a8b9a8,0xbb643b64,0x39a8b9a8,0xbaa73872,0x3b64b61f,0xbbd9323e
.long 0xbc00bc00,0x39a839a8,0x80008000,0xb9a8b9a8,0xb9a839a8,0x3bd9323e,0xb61fbb64,0xb8723aa7
.long 0x8000,0x3b64bb64,0xb9a839a8,0xb61f361f,0x39a8b9a8,0x38723aa7,0xbb64361f,0xb23ebbd9
.long 0xbc00bc00,0xb9a8b9a8,0x0,0x39a839a8,0xb9a839a8,0xb23e3bd9,0x361f3b64,0x3aa73872
.long 0x8000,0x361fb61f,0x39a8b9a8,0x3b64bb64,0x39a8b9a8,0x3aa7b872,0x3b64b61f,0x3bd9b23e
.long 0x80008000,0xb9a8b9a8,0xbc00bc00,0xb9a8b9a8,0xbc008000,0xb872baa7,0x361fbb64,0x3bd9b23e
.long 0x80008000,0x3b64bb64,0x39a8b9a8,0xb61f361f,0x3c008000,0x323ebbd9,0xbb64b61f,0xb8723aa7
.long 0x80008000,0xb9a8b9a8,0x3c003c00,0xb9a8b9a8,0xbc008000,0x3aa7b872,0xb61f3b64,0xb23ebbd9
.long 0x80008000,0x361fb61f,0xb9a839a8,0x3b64bb64,0x3c008000,0xbbd9b23e,0x3b64361f,0xbaa7b872
.long 0x80008000,0x39a839a8,0xbc00bc00,0x39a839a8,0xbc008000,0x38723aa7,0x361fbb64,0xbbd9323e
.long 0x80008000,0xbb643b64,0x39a8b9a8,0x361fb61f,0x3c008000,0xb23e3bd9,0xbb64b61f,0x3872baa7
.long 0x80008000,0x39a839a8,0x3c003c00,0x39a839a8,0xbc008000,0xbaa73872,0xb61f3b64,0x323e3bd9
.long 0x80008000,0xb61f361f,0xb9a839a8,0xbb643b64,0x3c008000,0x3bd9323e,0x3b64361f,0x3aa73872
.long 0x80008000,0x39a839a8,0x3c003c00,0x39a839a8,0x39a839a8,0xb23e3bd9,0xbb64361f,0xbaa7b872
.long 0xbc003c00,0xb61f361f,0x39a8b9a8,0x3b64bb64,0x39a839a8,0x3aa7b872,0xb61fbb64,0xbbd9323e
.long 0x80008000,0x39a839a8,0xbc00bc00,0x39a839a8,0x39a839a8,0xbbd9b23e,0x3b64b61f,0xb8723aa7
.long 0xbc003c00,0x3b64bb64,0xb9a839a8,0x361fb61f,0x39a839a8,0xb872baa7,0x361f3b64,0xb23ebbd9
.long 0x80008000,0xb9a8b9a8,0x3c003c00,0xb9a8b9a8,0x39a839a8,0x323ebbd9,0xbb64361f,0x3aa73872
.long 0xbc003c00,0x361fb61f,0x39a8b9a8,0xbb643b64,0x39a839a8,0xbaa73872,0xb61fbb64,0x3bd9b23e
.long 0x80008000,0xb9a8b9a8,0xbc00bc00,0xb9a8b9a8,0x39a839a8,0x3bd9323e,0x3b64b61f,0x3872baa7
.long 0xbc003c00,0xbb643b64,0xb9a839a8,0xb61f361f,0x39a839a8,0x38723aa7,0x361f3b64,0x323e3bd9
.long 0x80008000,0xb9a8b9a8,0xbc00bc00,0xb9a8b9a8,0x3c008000,0x38723aa7,0xb61f3b64,0xbbd9323e
.long 0x80008000,0x3b64bb64,0x39a8b9a8,0xb61f361f,0xbc008000,0xb23e3bd9,0x3b64361f,0x3872baa7
.long 0x80008000,0xb9a8b9a8,0x3c003c00,0xb9a8b9a8,0x3c008000,0xbaa73872,0x361fbb64,0x323e3bd9
.long 0x80008000,0x361fb61f,0xb9a839a8,0x3b64bb64,0xbc008000,0x3bd9323e,0xbb64b61f,0x3aa73872
.long 0x80008000,0x39a839a8,0xbc00bc00,0x39a839a8,0x3c008000,0xb872baa7,0xb61f3b64,0x3bd9b23e
.long 0x80008000,0xbb643b64,0x39a8b9a8,0x361fb61f,0xbc008000,0x323ebbd9,0x3b64361f,0xb8723aa7
.long 0x80008000,0x39a839a8,0x3c003c00,0x39a839a8,0x3c008000,0x3aa7b872,0x361fbb64,0xb23ebbd9
.long 0x80008000,0xb61f361f,0xb9a839a8,0xbb643b64,0xbc008000,0xbbd9b23e,0xbb64b61f,0xbaa7b872
.long 0x80008000,0x39a839a8,0x3c003c00,0x39a839a8,0xb9a8b9a8,0x323ebbd9,0x3b64b61f,0x3aa73872
.long 0xbc003c00,0xb61f361f,0x39a8b9a8,0x3b64bb64,0xb9a8b9a8,0xbaa73872,0x361f3b64,0x3bd9b23e
.long 0x80008000,0x39a839a8,0xbc00bc00,0x39a839a8,0xb9a8b9a8,0x3bd9323e,0xbb64361f,0x3872baa7
.long 0xbc003c00,0x3b64bb64,0xb9a839a8,0x361fb61f,0xb9a8b9a8,0x38723aa7,0xb61fbb64,0x323e3bd9
.long 0x80008000,0xb9a8b9a8,0x3c003c00,0xb9a8b9a8,0xb9a8b9a8,0xb23e3bd9,0x3b64b61f,0xbaa7b872
.long 0xbc003c00,0x361fb61f,0x39a8b9a8,0xbb643b64,0xb9a8b9a8,0x3aa7b872,0x361f3b64,0xbbd9323e
.long 0x80008000,0xb9a8b9a8,0xbc00bc00,0xb9a8b9a8,0xb9a8b9a8,0xbbd9b23e,0xbb64361f,0xb8723aa7
.long 0xbc003c00,0xbb643b64,0xb9a839a8,0xb61f361f,0xb9a8b9a8,0xb872baa7,0xb61fbb64,0xb23ebbd9
.long 0x3d800000,0x3d800000,0x3d800000,0x3d800000,0x3d800000,0x3d7ffb11,0x3d7fec43,0x3d7fd397
.long 0x3d800000,0x3d7fec43,0x3d7fb10f,0x3d7f4e6d,0x3d800000,0x3d7fd397,0x3d7f4e6d,0x3d7e70b0
.long 0x3d800000,0x3d7ec46d,0x3d7b14be,0x3d74fa0b,0x3d800000,0x3d7e70b0,0x3d79c79d,0x3d721352
.long 0x3d800000,0x3d7e1324,0x3d7853f8,0x3d6ed89e,0x3d800000,0x3d7dabcc,0x3d76ba07,0x3d6b4b0c
.long 0x3d800000,0x3d7b14be,0x3d6c835e,0x3d54db31,0x3d800000,0x3d7a7302,0x3d6a09a7,0x3d4f7a1f
.long 0x3d800000,0x3d79c79d,0x3d676bd8,0x3d49d112,0x3d800000,0x3d791298,0x3d64aa59,0x3d43e200
.long 0x3d800000,0x3d74fa0b,0x3d54db31,0x3d226799,0x3d800000,0x3d740bdd,0x3d514d3d,0x3d1b02c6
.long 0x3d800000,0x3d731447,0x3d4d9f02,0x3d13682a,0x3d800000,0x3d721352,0x3d49d112,0x3d0b9a6b
.long 0x3d800000,0x3d800000,0x3d800000,0x3d800000,0x3d7fb10f,0x3d7f84ab,0x3d7f4e6d,0x3d7f0e58
.long 0x3d7ec46d,0x3d7e1324,0x3d7d3aac,0x3d7c3b28,0x3d7d3aac,0x3d7baccd,0x3d79c79d,0x3d778bc5
.long 0x3d6c835e,0x3d61c598,0x3d54db31,0x3d45e403,0x3d676bd8,0x3d59f26a,0x3d49d112,0x3d373a23
.long 0x3d61c598,0x3d514d3d,0x3d3daef9,0x3d273656,0x3d5b941a,0x3d47de65,0x3d3085bb,0x3d15f6d9
.long 0x3d3504f3,0x3d0e39da,0x3cc3ef15,0x3c47c5c2,0x3d2beb4a,0x3d00e7e4,0x3ca09ae5,0x3be1bc2e
.long 0x3d226799,0x3ce63375,0x3c78cfcc,0x3ac90ab0,0x3d187fc0,0x3cc9b953,0x3c2f10a2,0xbb7b2b74
.long 0x3cc3ef15,0x3bc8bd36,0xbc47c5c2,0xbcf15aea,0x3cac7cd4,0x3b16c32c,0xbc888e93,0xbd0b9a6b
.long 0x3c94a031,0xbac90ab0,0xbcac7cd4,0xbd1d7fd1,0x3c78cfcc,0xbbafb680,0xbccf7bca,0xbd2e3bde
.long 0x3d800000,0x3d800000,0x3d800000,0x3d800000,0x3d7ec46d,0x3d7e70b0,0x3d7e1324,0x3d7dabcc
.long 0x3d7b14be,0x3d79c79d,0x3d7853f8,0x3d76ba07,0x3d74fa0b,0x3d721352,0x3d6ed89e,0x3d6b4b0c
.long 0x3d3504f3,0x3d226799,0x3d0e39da,0x3cf15aea,0x3d226799,0x3d0b9a6b,0x3ce63375,0x3cb263ef
.long 0x3d0e39da,0x3ce63375,0x3cac7cd4,0x3c605c13,0x3cf15aea,0x3cb263ef,0x3c605c13,0x3bafb680
.long 0x228d3132,0xbc47c5c2,0xbcc3ef15,0xbd0e39da,0xbbc8bd36,0xbc9aa086,0xbcfc5d27,0xbd299415
.long 0xbc47c5c2,0xbccf7bca,0xbd187fc0,0xbd41d870,0xbc94a031,0xbd00e7e4,0xbd3085bb,0xbd5695e5
.long 0xbd3504f3,0xbd61c598,0xbd7b14be,0xbd7ec46d,0xbd45e403,0xbd6db293,0xbd7f4e6d,0xbd791298
.long 0xbd54db31,0xbd76ba07,0xbd7fb10f,0xbd6ed89e,0xbd61c598,0xbd7cbfc9,0xbd7c3b28,0xbd604621
.long 0x3d800000,0x3d800000,0x3d800000,0x3d800000,0x3d7d3aac,0x3d7cbfc9,0x3d7c3b28,0x3d7baccd
.long 0x3d74fa0b,0x3d731447,0x3d710908,0x3d6ed89e,0x3d676bd8,0x3d633c5a,0x3d5ebe05,0x3d59f26a
.long 0x3cc3ef15,0x3c94a031,0x3c47c5c2,0x3bc8bd36,0x3c78cfcc,0x3c09cf86,0x3ac90ab0,0xbbafb680
.long 0x3bc8bd36,0xbac90ab0,0xbc164083,0xbc888e93,0xbb48fb30,0xbc3b6ecf,0xbca09ae5,0xbce0924f
.long 0xbd3504f3,0xbd54db31,0xbd6c835e,0xbd7b14be,0xbd4d9f02,0xbd68bf3c,0xbd79c79d,0xbd7ffb11
.long 0xbd61c598,0xbd76ba07,0xbd7fb10f,0xbd7c3b28,0xbd710908,0xbd7e70b0,0xbd7e1324,0xbd6ff573
.long 0xbd6c835e,0xbd45e403,0xbd0e39da,0xbc94a031,0xbd5b941a,0xbd299415,0xbccf7bca,0xbbe1bc2e
.long 0xbd45e403,0xbd08f59b,0xbc78cfcc,0x3b96a905,0xbd2beb4a,0xbcc9b953,0xbb96a905,0x3c827dc0
.long 0x0,0x0,0x0,0x0,0x0,0x3a490e90,0x3ac90ab0,0x3b16c32c
.long 0x0,0x3ac90ab0,0x3b48fb30,0x3b96a905,0x0,0x3b16c32c,0x3b96a905,0x3be1bc2e
.long 0x0,0x3bc8bd36,0x3c47c5c2,0x3c94a031,0x0,0x3be1bc2e,0x3c605c13,0x3ca68f12
.long 0x0,0x3bfab273,0x3c78cfcc,0x3cb8442a,0x0,0x3c09cf86,0x3c888e93,0x3cc9b953
.long 0x0,0x3c47c5c2,0x3cc3ef15,0x3d0e39da,0x0,0x3c541501,0x3ccf7bca,0x3d15f6d9
.long 0x0,0x3c605c13,0x3cdae880,0x3d1d7fd1,0x0,0x3c6c9a7f,0x3ce63375,0x3d24d225
.long 0x0,0x3c94a031,0x3d0e39da,0x3d45e403,0x0,0x3c9aa086,0x3d13682a,0x3d4bbbf8
.long 0x0,0x3ca09ae5,0x3d187fc0,0x3d514d3d,0x0,0x3ca68f12,0x3d1d7fd1,0x3d5695e5
.long 0x0,0x0,0x0,0x0,0x3b48fb30,0x3b7b2b74,0x3b96a905,0x3bafb680
.long 0x3bc8bd36,0x3bfab273,0x3c164083,0x3c2f10a2,0x3c164083,0x3c3b6ecf,0x3c605c13,0x3c827dc0
.long 0x3cc3ef15,0x3cf15aea,0x3d0e39da,0x3d226799,0x3cdae880,0x3d064b82,0x3d1d7fd1,0x3d32c8c9
.long 0x3cf15aea,0x3d13682a,0x3d2beb4a,0x3d41d870,0x3d039c3d,0x3d1ff6cb,0x3d396842,0x3d4f7a1f
.long 0x3d3504f3,0x3d54db31,0x3d6c835e,0x3d7b14be,0x3d3daef9,0x3d5d2d53,0x3d731447,0x3d7e70b0
.long 0x3d45e403,0x3d64aa59,0x3d7853f8,0x3d7fec43,0x3d4d9f02,0x3d6b4b0c,0x3d7c3b28,0x3d7f84ab
.long 0x3d6c835e,0x3d7ec46d,0x3d7b14be,0x3d61c598,0x3d710908,0x3d7fd397,0x3d76ba07,0x3d5695e5
.long 0x3d74fa0b,0x3d7fec43,0x3d710908,0x3d49d112,0x3d7853f8,0x3d7f0e58,0x3d6a09a7,0x3d3b8f3b
.long 0x0,0x0,0x0,0x0,0x3bc8bd36,0x3be1bc2e,0x3bfab273,0x3c09cf86
.long 0x3c47c5c2,0x3c605c13,0x3c78cfcc,0x3c888e93,0x3c94a031,0x3ca68f12,0x3cb8442a,0x3cc9b953
.long 0x3d3504f3,0x3d45e403,0x3d54db31,0x3d61c598,0x3d45e403,0x3d5695e5,0x3d64aa59,0x3d6ff573
.long 0x3d54db31,0x3d64aa59,0x3d710908,0x3d79c79d,0x3d61c598,0x3d6ff573,0x3d79c79d,0x3d7f0e58
.long 0x3d800000,0x3d7b14be,0x3d6c835e,0x3d54db31,0x3d7ec46d,0x3d740bdd,0x3d5ebe05,0x3d3fc767
.long 0x3d7b14be,0x3d6a09a7,0x3d4d9f02,0x3d273656,0x3d74fa0b,0x3d5d2d53,0x3d396842,0x3d0b9a6b
.long 0x3d3504f3,0x3cf15aea,0x3c47c5c2,0xbbc8bd36,0x3d226799,0x3cbe1d4a,0x3b96a905,0xbc6c9a7f
.long 0x3d0e39da,0x3c888e93,0xbb48fb30,0xbcb8442a,0x3cf15aea,0x3c22abb6,0xbc2f10a2,0xbcf6e0cb
.long 0x0,0x0,0x0,0x0,0x3c164083,0x3c22abb6,0x3c2f10a2,0x3c3b6ecf
.long 0x3c94a031,0x3ca09ae5,0x3cac7cd4,0x3cb8442a,0x3cdae880,0x3cebcbbb,0x3cfc5d27,0x3d064b82
.long 0x3d6c835e,0x3d74fa0b,0x3d7b14be,0x3d7ec46d,0x3d7853f8,0x3d7dabcc,0x3d7fec43,0x3d7f0e58
.long 0x3d7ec46d,0x3d7fec43,0x3d7d3aac,0x3d76ba07,0x3d7fb10f,0x3d7baccd,0x3d731447,0x3d660f88
.long 0x3d3504f3,0x3d0e39da,0x3cc3ef15,0x3c47c5c2,0x3d187fc0,0x3cd53641,0x3c605c13,0x3a490e90
.long 0x3cf15aea,0x3c888e93,0x3b48fb30,0xbc2f10a2,0x3cac7cd4,0x3be1bc2e,0xbbfab273,0xbcb263ef
.long 0xbcc3ef15,0xbd226799,0xbd54db31,0xbd74fa0b,0xbd039c3d,0xbd3fc767,0xbd6a09a7,0xbd7e70b0
.long 0xbd226799,0xbd584853,0xbd7853f8,0xbd7f4e6d,0xbd3daef9,0xbd6b4b0c,0xbd7f4e6d,0xbd778bc5
.long 0x3d800000,0x3d7fb10f,0x3d7ec46d,0x3d7d3aac,0x3d800000,0x3d7f84ab,0x3d7e1324,0x3d7baccd
.long 0x3d800000,0x3d7f4e6d,0x3d7d3aac,0x3d79c79d,0x3d800000,0x3d7f0e58,0x3d7c3b28,0x3d778bc5
.long 0x3d800000,0x3d7d3aac,0x3d74fa0b,0x3d676bd8,0x3d800000,0x3d7cbfc9,0x3d731447,0x3d633c5a
.long 0x3d800000,0x3d7c3b28,0x3d710908,0x3d5ebe05,0x3d800000,0x3d7baccd,0x3d6ed89e,0x3d59f26a
.long 0x3d800000,0x3d7853f8,0x3d61c598,0x3d3daef9,0x3d800000,0x3d778bc5,0x3d5ebe05,0x3d373a23
.long 0x3d800000,0x3d76ba07,0x3d5b941a,0x3d3085bb,0x3d800000,0x3d75dec6,0x3d584853,0x3d299415
.long 0x3d800000,0x3d710908,0x3d45e403,0x3d039c3d,0x3d800000,0x3d6ff573,0x3d41d870,0x3cf6e0cb
.long 0x3d800000,0x3d6ed89e,0x3d3daef9,0x3ce63375,0x3d800000,0x3d6db293,0x3d396842,0x3cd53641
.long 0x3d7b14be,0x3d7853f8,0x3d74fa0b,0x3d710908,0x3d7853f8,0x3d740bdd,0x3d6ed89e,0x3d68bf3c
.long 0x3d74fa0b,0x3d6ed89e,0x3d676bd8,0x3d5ebe05,0x3d710908,0x3d68bf3c,0x3d5ebe05,0x3d531849
.long 0x3d54db31,0x3d3daef9,0x3d226799,0x3d039c3d,0x3d4d9f02,0x3d32c8c9,0x3d13682a,0x3ce0924f
.long 0x3d45e403,0x3d273656,0x3d039c3d,0x3cb8442a,0x3d3daef9,0x3d1b02c6,0x3ce63375,0x3c8e9a22
.long 0x3d0e39da,0x3cac7cd4,0x3bc8bd36,0xbc164083,0x3d039c3d,0x3c8e9a22,0x3ac90ab0,0xbc6c9a7f
.long 0x3cf15aea,0x3c605c13,0xbb48fb30,0xbca09ae5,0x3cdae880,0x3c22abb6,0xbbfab273,0xbcc9b953
.long 0x3c47c5c2,0xbc164083,0xbcf15aea,0xbd3daef9,0x3c164083,0xbc541501,0xbd08f59b,0xbd4bbbf8
.long 0x3bc8bd36,0xbc888e93,0xbd187fc0,0xbd584853,0x3b48fb30,0xbca68f12,0xbd273656,0xbd633c5a
.long 0x3d6c835e,0x3d676bd8,0x3d61c598,0x3d5b941a,0x3d61c598,0x3d59f26a,0x3d514d3d,0x3d47de65
.long 0x3d54db31,0x3d49d112,0x3d3daef9,0x3d3085bb,0x3d45e403,0x3d373a23,0x3d273656,0x3d15f6d9
.long 0x3cc3ef15,0x3c78cfcc,0x3bc8bd36,0xbb48fb30,0x3c94a031,0x3c09cf86,0xbac90ab0,0xbc3b6ecf
.long 0x3c47c5c2,0x3ac90ab0,0xbc164083,0xbca09ae5,0x3bc8bd36,0xbbafb680,0xbc888e93,0xbce0924f
.long 0xbcc3ef15,0xbd187fc0,0xbd45e403,0xbd676bd8,0xbcf15aea,0xbd2e3bde,0xbd584853,0xbd740bdd
.long 0xbd0e39da,0xbd41d870,0xbd676bd8,0xbd7c3b28,0xbd226799,0xbd531849,0xbd731447,0xbd7fd397
.long 0xbd6c835e,0xbd7fb10f,0xbd74fa0b,0xbd4d9f02,0xbd74fa0b,0xbd7f84ab,0xbd6a09a7,0xbd373a23
.long 0xbd7b14be,0xbd7c3b28,0xbd5b941a,0xbd1d7fd1,0xbd7ec46d,0xbd75dec6,0xbd49d112,0xbd00e7e4
.long 0x3d54db31,0x3d4d9f02,0x3d45e403,0x3d3daef9,0x3d3daef9,0x3d32c8c9,0x3d273656,0x3d1b02c6
.long 0x3d226799,0x3d13682a,0x3d039c3d,0x3ce63375,0x3d039c3d,0x3ce0924f,0x3cb8442a,0x3c8e9a22
.long 0xbc47c5c2,0xbcac7cd4,0xbcf15aea,0xbd187fc0,0xbcac7cd4,0xbcf6e0cb,0xbd1d7fd1,0xbd3b8f3b
.long 0xbcf15aea,0xbd1d7fd1,0xbd3daef9,0xbd584853,0xbd187fc0,0xbd3b8f3b,0xbd584853,0xbd6db293
.long 0xbd7b14be,0xbd7fb10f,0xbd74fa0b,0xbd5b941a,0xbd7fb10f,0xbd7a7302,0xbd64aa59,0xbd3fc767
.long 0xbd7ec46d,0xbd6ed89e,0xbd4d9f02,0xbd1d7fd1,0xbd7853f8,0xbd5d2d53,0xbd3085bb,0xbcebcbbb
.long 0xbd0e39da,0xbc78cfcc,0x3bc8bd36,0x3cdae880,0xbcdae880,0xbbafb680,0x3c888e93,0x3d15f6d9
.long 0xbc94a031,0x3b96a905,0x3cdae880,0x3d396842,0xbc164083,0x3c6c9a7f,0x3d13682a,0x3d5695e5
.long 0x0,0x3b48fb30,0x3bc8bd36,0x3c164083,0x0,0x3b7b2b74,0x3bfab273,0x3c3b6ecf
.long 0x0,0x3b96a905,0x3c164083,0x3c605c13,0x0,0x3bafb680,0x3c2f10a2,0x3c827dc0
.long 0x0,0x3c164083,0x3c94a031,0x3cdae880,0x0,0x3c22abb6,0x3ca09ae5,0x3cebcbbb
.long 0x0,0x3c2f10a2,0x3cac7cd4,0x3cfc5d27,0x0,0x3c3b6ecf,0x3cb8442a,0x3d064b82
.long 0x0,0x3c78cfcc,0x3cf15aea,0x3d2beb4a,0x0,0x3c827dc0,0x3cfc5d27,0x3d32c8c9
.long 0x0,0x3c888e93,0x3d039c3d,0x3d396842,0x0,0x3c8e9a22,0x3d08f59b,0x3d3fc767
.long 0x0,0x3cac7cd4,0x3d226799,0x3d5b941a,0x0,0x3cb263ef,0x3d273656,0x3d604621
.long 0x0,0x3cb8442a,0x3d2beb4a,0x3d64aa59,0x0,0x3cbe1d4a,0x3d3085bb,0x3d68bf3c
.long 0x3c47c5c2,0x3c78cfcc,0x3c94a031,0x3cac7cd4,0x3c78cfcc,0x3c9aa086,0x3cb8442a,0x3cd53641
.long 0x3c94a031,0x3cb8442a,0x3cdae880,0x3cfc5d27,0x3cac7cd4,0x3cd53641,0x3cfc5d27,0x3d10d3cd
.long 0x3d0e39da,0x3d2beb4a,0x3d45e403,0x3d5b941a,0x3d187fc0,0x3d373a23,0x3d514d3d,0x3d660f88
.long 0x3d226799,0x3d41d870,0x3d5b941a,0x3d6ed89e,0x3d2beb4a,0x3d4bbbf8,0x3d64aa59,0x3d75dec6
.long 0x3d54db31,0x3d710908,0x3d7ec46d,0x3d7d3aac,0x3d5b941a,0x3d75dec6,0x3d7fec43,0x3d791298
.long 0x3d61c598,0x3d79c79d,0x3d7fb10f,0x3d731447,0x3d676bd8,0x3d7cbfc9,0x3d7e1324,0x3d6b4b0c
.long 0x3d7b14be,0x3d7d3aac,0x3d61c598,0x3d2beb4a,0x3d7d3aac,0x3d7a7302,0x3d584853,0x3d1b02c6
.long 0x3d7ec46d,0x3d76ba07,0x3d4d9f02,0x3d08f59b,0x3d7fb10f,0x3d721352,0x3d41d870,0x3cebcbbb
.long 0x3cc3ef15,0x3cdae880,0x3cf15aea,0x3d039c3d,0x3cf15aea,0x3d064b82,0x3d13682a,0x3d1ff6cb
.long 0x3d0e39da,0x3d1d7fd1,0x3d2beb4a,0x3d396842,0x3d226799,0x3d32c8c9,0x3d41d870,0x3d4f7a1f
.long 0x3d6c835e,0x3d7853f8,0x3d7ec46d,0x3d7fb10f,0x3d74fa0b,0x3d7dabcc,0x3d7fec43,0x3d7baccd
.long 0x3d7b14be,0x3d7fec43,0x3d7d3aac,0x3d731447,0x3d7ec46d,0x3d7f0e58,0x3d76ba07,0x3d660f88
.long 0x3d6c835e,0x3d4d9f02,0x3d226799,0x3cdae880,0x3d61c598,0x3d3b8f3b,0x3d08f59b,0x3c9aa086
.long 0x3d54db31,0x3d273656,0x3cdae880,0x3c2f10a2,0x3d45e403,0x3d10d3cd,0x3ca09ae5,0x3b16c32c
.long 0x3cc3ef15,0x3b48fb30,0xbc94a031,0xbd187fc0,0x3c94a031,0xbb7b2b74,0xbccf7bca,0xbd32c8c9
.long 0x3c47c5c2,0xbc2f10a2,0xbd039c3d,0xbd49d112,0x3bc8bd36,0xbc8e9a22,0xbd1d7fd1,0xbd5d2d53
.long 0x3d0e39da,0x3d187fc0,0x3d226799,0x3d2beb4a,0x3d2beb4a,0x3d373a23,0x3d41d870,0x3d4bbbf8
.long 0x3d45e403,0x3d514d3d,0x3d5b941a,0x3d64aa59,0x3d5b941a,0x3d660f88,0x3d6ed89e,0x3d75dec6
.long 0x3d7b14be,0x3d710908,0x3d61c598,0x3d4d9f02,0x3d710908,0x3d604621,0x3d49d112,0x3d2e3bde
.long 0x3d61c598,0x3d49d112,0x3d2beb4a,0x3d08f59b,0x3d4d9f02,0x3d2e3bde,0x3d08f59b,0x3cbe1d4a
.long 0x3c47c5c2,0xbb48fb30,0xbc94a031,0xbd039c3d,0x3b48fb30,0xbc541501,0xbce63375,0xbd299415
.long 0xbbc8bd36,0xbcb8442a,0xbd187fc0,0xbd49d112,0xbc78cfcc,0xbd00e7e4,0xbd396842,0xbd633c5a
.long 0xbd54db31,0xbd7853f8,0xbd7ec46d,0xbd676bd8,0xbd676bd8,0xbd7f0e58,0xbd76ba07,0xbd4f7a1f
.long 0xbd74fa0b,0xbd7f4e6d,0xbd676bd8,0xbd3085bb,0xbd7d3aac,0xbd791298,0xbd514d3d,0xbd0b9a6b
.long 0x54005400,0x54005400,0x54005400,0x54005400,0x50545400,0xd0540000,0x553a5400,0x553a55a8
.long 0x5400,0xd5a8d400,0x55a85400,0x5400,0xd0545400,0xd054d5a8,0x553a5400,0xd53a0000
.long 0xd4005400,0x5400d400,0x54005400,0xd400d400,0xd53a5400,0x553a8000,0x50545400,0x5054d5a8
.long 0xd5a85400,0x5400,0x5400,0x55a8d400,0xd53a5400,0xd53a55a8,0xd0545400,0x50548000
.long 0xd4005400,0xd4005400,0xd4005400,0xd4005400,0xd0545400,0x50540000,0xd53a5400,0xd53a55a8
.long 0x80005400,0x55a8d400,0xd5a85400,0x80005400,0x50545400,0x5054d5a8,0xd53a5400,0x553a0000
.long 0x54005400,0xd400d400,0xd4005400,0x5400d400,0x553a5400,0xd53a8000,0xd0545400,0xd054d5a8
.long 0x55a85400,0x80005400,0x80005400,0xd5a8d400,0x553a5400,0x553a55a8,0x50545400,0xd0548000
.long 0x54005400,0x54005400,0x54005400,0x54005400,0xd53ad400,0xd53ad5a8,0x50545400,0xd0540000
.long 0x8000d400,0x55a85400,0xd5a8d400,0x8000d400,0x553a5400,0xd53a0000,0x5054d400,0x505455a8
.long 0xd4005400,0x5400d400,0x54005400,0xd400d400,0xd054d400,0xd05455a8,0xd53a5400,0x553a8000
.long 0x55a8d400,0x8000d400,0x8000d400,0xd5a85400,0xd0545400,0x50548000,0x553ad400,0x553ad5a8
.long 0xd4005400,0xd4005400,0xd4005400,0xd4005400,0x553ad400,0x553ad5a8,0xd0545400,0x50540000
.long 0xd400,0xd5a85400,0x55a8d400,0xd400,0xd53a5400,0x553a0000,0xd054d400,0xd05455a8
.long 0x54005400,0xd400d400,0xd4005400,0x5400d400,0x5054d400,0x505455a8,0x553a5400,0xd53a8000
.long 0xd5a8d400,0xd400,0xd400,0x55a85400,0x50545400,0xd0548000,0xd53ad400,0xd53ad5a8
.long 0x54005400,0x54005400,0x54005400,0x54005400,0xd054d400,0x50548000,0xd53ad400,0xd53ad5a8
.long 0x5400,0xd5a8d400,0x55a85400,0x5400,0x5054d400,0x505455a8,0xd53ad400,0x553a8000
.long 0xd4005400,0x5400d400,0x54005400,0xd400d400,0x553ad400,0xd53a0000,0xd054d400,0xd05455a8
.long 0xd5a85400,0x5400,0x5400,0x55a8d400,0x553ad400,0x553ad5a8,0x5054d400,0xd0540000
.long 0xd4005400,0xd4005400,0xd4005400,0xd4005400,0x5054d400,0xd0548000,0x553ad400,0x553ad5a8
.long 0x80005400,0x55a8d400,0xd5a85400,0x80005400,0xd054d400,0xd05455a8,0x553ad400,0xd53a8000
.long 0x54005400,0xd400d400,0xd4005400,0x5400d400,0xd53ad400,0x553a0000,0x5054d400,0x505455a8
.long 0x55a85400,0x80005400,0x80005400,0xd5a8d400,0xd53ad400,0xd53ad5a8,0xd054d400,0x50540000
.long 0x54005400,0x54005400,0x54005400,0x54005400,0x553a5400,0x553a55a8,0xd054d400,0x50548000
.long 0x8000d400,0x55a85400,0xd5a8d400,0x8000d400,0xd53ad400,0x553a8000,0xd0545400,0xd054d5a8
.long 0xd4005400,0x5400d400,0x54005400,0xd400d400,0x50545400,0x5054d5a8,0x553ad400,0xd53a0000
.long 0x55a8d400,0x8000d400,0x8000d400,0xd5a85400,0x5054d400,0xd0540000,0xd53a5400,0xd53a55a8
.long 0xd4005400,0xd4005400,0xd4005400,0xd4005400,0xd53a5400,0xd53a55a8,0x5054d400,0xd0548000
.long 0xd400,0xd5a85400,0x55a8d400,0xd400,0x553ad400,0xd53a8000,0x50545400,0x5054d5a8
.long 0x54005400,0xd400d400,0xd4005400,0x5400d400,0xd0545400,0xd054d5a8,0xd53ad400,0x553a0000
.long 0xd5a8d400,0xd400,0xd400,0x55a85400,0xd054d400,0x50540000,0x553a5400,0x553a55a8
.p2align 6
.amdhsa_kernel interleave_layers__spectral_fnet__moe_arch_mod__prompt_kernel
  .amdhsa_next_free_vgpr 256
  .amdhsa_next_free_sgpr 102
  .amdhsa_accum_offset 256
  .amdhsa_group_segment_fixed_size 0
  .amdhsa_kernarg_size 104
  .amdhsa_user_sgpr_count 2
  .amdhsa_user_sgpr_kernarg_segment_ptr 1
  .amdhsa_system_sgpr_workgroup_id_x 1
.end_amdhsa_kernel
```
